```python
import torch

def _softmax(x, axis=-1):
    return torch.softmax(x, dim=axis)
def _gelu(x):
    return torch.nn.functional.gelu(x, approximate="tanh")
def _silu(x):
    return torch.nn.functional.silu(x)
def _sigmoid(x):
    return torch.sigmoid(x)
def _layernorm(x, axis=-1, eps=1e-5):
    m = x.mean(dim=axis, keepdim=True)
    v = x.var(dim=axis, keepdim=True, unbiased=False)
    return (x - m) / torch.sqrt(v + eps)
def _scatter_add(tgt, idx, src, axis=0):
    return tgt.clone().index_add_(axis, idx, src)
def _segment_sum(src, seg, n):
    out = torch.zeros((n,) + src.shape[1:], dtype=src.dtype)
    return out.index_add_(0, seg, src)
def _pad(x, pw):
    flat = tuple(v for pair in reversed(pw) for v in pair)
    return torch.nn.functional.pad(x, flat)

kernel_name = 'parallel_sum__spectral_fnet__swiglu_ffn__prompt'

def setup_inputs():

    _w = (lambda a: (lambda t: t.to(torch.bfloat16) if t.is_floating_point() else t)(torch.as_tensor(a)))
    def _A_setup():
        B, S, D = 1, 2048, 640
        ns = torch.arange(S)[:, None] * torch.arange(S)[None, :]
        nd = torch.arange(D)[:, None] * torch.arange(D)[None, :]
        Ws_re = torch.cos(-2.0 * torch.pi * ns / S).to(float)
        Ws_im = torch.sin(-2.0 * torch.pi * ns / S).to(float)
        Wd_re = torch.cos(-2.0 * torch.pi * nd / D).to(float)
        Wd_im = torch.sin(-2.0 * torch.pi * nd / D).to(float)
        return {
            "x": _w((lambda *s: torch.randn(*s, dtype=torch.bfloat16) * 0.05)(B, S, D)),
            "dft_seq_re": _w(Ws_re),
            "dft_seq_im": _w(Ws_im),
            "dft_hid_re": _w(Wd_re),
            "dft_hid_im": _w(Wd_im),
        }
    _A_in = _A_setup()

    def _B_setup():
        B, S, D, F = 1, 2048, 640, 1536
        return {
            "x": _w((lambda *s: torch.randn(*s, dtype=torch.bfloat16) * 0.05)(B, S, D)),
            "w_gate": _w((lambda *s: torch.randn(*s, dtype=torch.bfloat16) * 0.2)(D, F)),
            "w_up": _w((lambda *s: torch.randn(*s, dtype=torch.bfloat16) * 0.2)(D, F)),
            "w_down": _w((lambda *s: torch.randn(*s, dtype=torch.bfloat16) * 0.2)(F, D)),
        }
    _B_in = _B_setup()

    return {
        "A_x": _A_in["x"],
        "A_dft_seq_re": _A_in["dft_seq_re"],
        "A_dft_seq_im": _A_in["dft_seq_im"],
        "A_dft_hid_re": _A_in["dft_hid_re"],
        "A_dft_hid_im": _A_in["dft_hid_im"],
        "B_x": _B_in["x"],
        "B_w_gate": _B_in["w_gate"],
        "B_w_up": _B_in["w_up"],
        "B_w_down": _B_in["w_down"],
    }

def reference(A_x, A_dft_seq_re, A_dft_seq_im, A_dft_hid_re, A_dft_hid_im, B_x, B_w_gate, B_w_up, B_w_down):
    def _A_ref(x, dft_seq_re, dft_seq_im, dft_hid_re, dft_hid_im):
        a = torch.einsum("bsd,ed->bse", x, dft_hid_re)
        b = torch.einsum("bsd,ed->bse", x, dft_hid_im)
        y = torch.einsum("ts,bse->bte", dft_seq_re, a) - torch.einsum("ts,bse->bte", dft_seq_im, b)
        return y

    def _B_ref(x, w_gate, w_up, w_down):
        g = _silu(x @ w_gate)
        u = x @ w_up
        return (g * u) @ w_down

    x = A_x
    xn = _layernorm(x, axis=-1)
    return x + _A_ref(xn, A_dft_seq_re, A_dft_seq_im, A_dft_hid_re, A_dft_hid_im) + _B_ref(xn, B_w_gate, B_w_up, B_w_down)
```

```asm
; @launch grid=(256,1,1) block=(512,1,1) lds=163840
.amdgcn_target "amdgcn-amd-amdhsa--gfx950"
.text
.globl parallel_sum__spectral_fnet__swiglu_ffn__prompt_kernel
.p2align 8
.type parallel_sum__spectral_fnet__swiglu_ffn__prompt_kernel,@function
parallel_sum__spectral_fnet__swiglu_ffn__prompt_kernel:
    s_cmp_ge_u32 s2, 256
    s_cbranch_scc1 L_done
    s_load_dwordx2 s[64:65], s[0:1], 0
    s_load_dwordx4 s[60:63], s[0:1], 24
    s_load_dwordx8 s[48:55], s[0:1], 48
    s_load_dwordx4 s[56:59], s[0:1], 80
    v_lshrrev_b32 v1, 6, v0
    v_and_b32 v0, 63, v0
    v_readfirstlane_b32 s3, v1
    s_and_b32 s40, s2, 7
    s_lshr_b32 s41, s2, 3
    s_and_b32 s31, s40, 1
    s_lshr_b32 s30, s40, 1
    s_and_b32 s32, s41, 7
    s_lshr_b32 s33, s41, 3
    s_lshl_b32 s28, s31, 3
    s_add_u32 s28, s28, s32
    s_mul_i32 s29, s30, 3
    s_add_u32 s29, s29, s33
    s_add_u32 s42, s30, 12
    s_cmp_eq_u32 s33, 3
    s_cselect_b32 s29, s42, s29
    s_cselect_b32 s35, 1, 0
    s_mov_b32 s34, 0
    s_mul_i32 s42, s31, 5
    s_add_u32 s34, s34, s42
    s_cmp_ge_u32 s34, 10
    s_cselect_b32 s42, 10, 0
    s_sub_u32 s34, s34, s42
    s_lshl_b32 s42, s40, 2
    s_add_u32 s42, s42, s33
    s_mov_b32 s38, s32
    s_lshl_b32 s39, s33, 1
    s_add_u32 s39, s39, s32
    s_mul_i32 s39, s39, 3
    s_lshr_b32 s39, s39, 2
    s_cmp_ge_u32 s39, 6
    s_cselect_b32 s66, 6, 0
    s_sub_u32 s39, s39, s66
    s_and_b32 s39, s2, 7
    s_mul_i32 s39, s39, 3
    s_lshr_b32 s39, s39, 2
    s_lshr_b32 s36, s42, 1
    s_and_b32 s37, s42, 1
    s_cmp_lt_u32 s3, 4
    s_cbranch_scc1 L_compute
    s_sub_u32 s44, s3, 4
    s_cmp_eq_u32 s44, 3
    s_cbranch_scc1 L_aux
    s_cmp_eq_u32 s44, 2
    s_cbranch_scc1 L_ldx
    s_cmp_eq_u32 s35, 1
    s_cbranch_scc1 L_ldc
    v_lshrrev_b32 v1, 4, v0
    v_and_b32 v2, 15, v0
    v_lshlrev_b32 v3, 1, v1
    v_xor_b32 v2, v2, v3
    v_lshlrev_b32 v2, 4, v2
    v_mul_u32_u24 v3, 3072, v1
    v_add_u32 v2, v2, v3
    s_lshl_b32 s70, s29, 8
    v_add_u32 v2, s70, v2
    s_and_b32 s70, s32, 1
    s_lshl_b32 s70, s70, 7
    v_xor_b32 v4, s70, v2
    v_xor_b32 v5, 128, v4
    s_lshl_b32 s70, s32, 11
    s_lshl_b32 s71, s44, 14
    s_or_b32 s20, s70, s71
    s_mul_i32 s66, s70, 12
    s_add_u32 s22, s20, 1024
    s_add_u32 s68, s66, 12288
    s_add_u32 s70, s70, 2048
    s_and_b32 s70, s70, 0x3c00
    s_or_b32 s21, s70, s71
    s_mul_i32 s67, s70, 12
    s_add_u32 s23, s21, 1024
    s_add_u32 s69, s67, 12288
    s_add_u32 s70, s70, 2048
    s_and_b32 s70, s70, 0x3c00
    s_or_b32 s24, s70, s71
    s_mul_i32 s76, s70, 12
    s_add_u32 s26, s24, 1024
    s_add_u32 s78, s76, 12288
    s_add_u32 s70, s70, 2048
    s_and_b32 s70, s70, 0x3c00
    s_or_b32 s25, s70, s71
    s_mul_i32 s77, s70, 12
    s_add_u32 s27, s25, 1024
    s_add_u32 s79, s77, 12288
    s_add_u32 s70, s70, 2048
    s_and_b32 s70, s70, 0x3c00
    s_or_b32 s4, s70, s71
    s_mul_i32 s28, s70, 12
    s_add_u32 s6, s4, 1024
    s_add_u32 s30, s28, 12288
    s_add_u32 s70, s70, 2048
    s_and_b32 s70, s70, 0x3c00
    s_or_b32 s5, s70, s71
    s_mul_i32 s29, s70, 12
    s_add_u32 s7, s5, 1024
    s_add_u32 s31, s29, 12288
    s_add_u32 s70, s70, 2048
    s_and_b32 s70, s70, 0x3c00
    s_or_b32 s16, s70, s71
    s_mul_i32 s40, s70, 12
    s_add_u32 s18, s16, 1024
    s_add_u32 s33, s40, 12288
    s_add_u32 s70, s70, 2048
    s_and_b32 s70, s70, 0x3c00
    s_or_b32 s17, s70, s71
    s_mul_i32 s41, s70, 12
    s_add_u32 s19, s17, 1024
    s_add_u32 s43, s41, 12288
    s_cmp_eq_u32 s44, 1
    s_waitcnt lgkmcnt(0)
    s_cselect_b32 s8, s50, s48
    s_cselect_b32 s9, s51, s49
    s_mov_b32 s10, 1966080
    s_mov_b32 s11, 0x00020000
    s_mov_b32 s48, 196608
    s_mov_b32 s51, s48
    s_mov_b32 s45, s34
    s_mul_i32 s42, s34, s48
    s_mul_i32 s49, s48, -9
    s_branch L_ld16
L_ldx:
    s_min_u32 s72, s30, 1
    s_add_u32 s71, s30, s72
    s_mul_i32 s72, s31, 3
    s_add_u32 s71, s71, s72
    s_cmp_ge_u32 s71, 5
    s_cselect_b32 s72, 5, 0
    s_sub_u32 s71, s71, s72
    v_lshrrev_b32 v1, 3, v0
    v_and_b32 v2, 7, v0
    v_lshrrev_b32 v3, 1, v1
    v_xor_b32 v2, v2, v3
    v_lshlrev_b32 v2, 4, v2
    v_lshrrev_b32 v3, 2, v1
    v_and_b32 v6, 3, v1
    v_lshl_add_u32 v3, v6, 2, v3
    v_lshlrev_b32 v3, 7, v3
    v_add_u32 v3, s28, v3
    v_mul_u32_u24 v3, 1280, v3
    v_add_u32 v4, v2, v3
    v_xor_b32 v5, 64, v4
    v_add_u32 v5, 327680, v5
    s_lshl_b32 s70, s33, 12
    s_or_b32 s20, s70, 0x8000
    s_or_b32 s21, s70, 0x8400
    s_mul_i32 s66, s70, 10
    s_mov_b32 s67, s66
    s_add_u32 s70, s70, 2048
    s_and_b32 s70, s70, 0x3c00
    s_or_b32 s22, s70, 0x8000
    s_or_b32 s23, s70, 0x8400
    s_mul_i32 s68, s70, 10
    s_mov_b32 s69, s68
    s_add_u32 s70, s70, 2048
    s_and_b32 s70, s70, 0x3c00
    s_or_b32 s24, s70, 0x8000
    s_or_b32 s25, s70, 0x8400
    s_mul_i32 s76, s70, 10
    s_mov_b32 s77, s76
    s_add_u32 s70, s70, 2048
    s_and_b32 s70, s70, 0x3c00
    s_or_b32 s26, s70, 0x8000
    s_or_b32 s27, s70, 0x8400
    s_mul_i32 s78, s70, 10
    s_mov_b32 s79, s78
    s_add_u32 s70, s70, 2048
    s_and_b32 s70, s70, 0x3c00
    s_or_b32 s4, s70, 0x8000
    s_or_b32 s5, s70, 0x8400
    s_mul_i32 s28, s70, 10
    s_mov_b32 s29, s28
    s_add_u32 s70, s70, 2048
    s_and_b32 s70, s70, 0x3c00
    s_or_b32 s6, s70, 0x8000
    s_or_b32 s7, s70, 0x8400
    s_mul_i32 s30, s70, 10
    s_mov_b32 s31, s30
    s_add_u32 s70, s70, 2048
    s_and_b32 s70, s70, 0x3c00
    s_or_b32 s16, s70, 0x8000
    s_or_b32 s17, s70, 0x8400
    s_mul_i32 s40, s70, 10
    s_mov_b32 s41, s40
    s_add_u32 s70, s70, 2048
    s_and_b32 s70, s70, 0x3c00
    s_or_b32 s18, s70, 0x8000
    s_or_b32 s19, s70, 0x8400
    s_mul_i32 s33, s70, 10
    s_mov_b32 s43, s33
    s_waitcnt lgkmcnt(0)
    s_mov_b32 s8, s64
    s_mov_b32 s9, s65
    s_mov_b32 s10, 2621440
    s_mov_b32 s11, 0x00020000
    s_movk_i32 s48, 128
    s_movk_i32 s51, 128
    s_mov_b32 s45, s34
    s_lshl_b32 s42, s34, 7
    s_movk_i32 s49, -1152
    s_cmp_eq_u32 s35, 0
    s_cbranch_scc1 L_ld16
    s_movk_i32 s48, 640
    s_movk_i32 s51, -512
    s_lshl_b32 s45, s71, 1
    s_lshl_b32 s42, s71, 7
L_ld16:
    s_mov_b32 s46, 0
    s_mov_b32 s47, 0
    v_add_u32 v4, s42, v4
    v_add_u32 v5, s42, v5
L_ldw_l:
    s_add_u32 m0, s20, s46
    s_nop 0
    buffer_load_dwordx4 v4, s[8:11], s66 offen  lds
    s_add_u32 m0, s21, s46
    s_nop 0
    buffer_load_dwordx4 v5, s[8:11], s67 offen  lds
    s_add_u32 m0, s22, s46
    s_nop 0
    buffer_load_dwordx4 v4, s[8:11], s68 offen  lds
    s_add_u32 m0, s23, s46
    s_nop 0
    buffer_load_dwordx4 v5, s[8:11], s69 offen  lds
    s_add_u32 m0, s24, s46
    s_nop 0
    buffer_load_dwordx4 v4, s[8:11], s76 offen  lds
    s_add_u32 m0, s25, s46
    s_nop 0
    buffer_load_dwordx4 v5, s[8:11], s77 offen  lds
    s_add_u32 m0, s26, s46
    s_nop 0
    buffer_load_dwordx4 v4, s[8:11], s78 offen  lds
    s_add_u32 m0, s27, s46
    s_nop 0
    buffer_load_dwordx4 v5, s[8:11], s79 offen  lds
    s_add_u32 m0, s4, s46
    s_nop 0
    buffer_load_dwordx4 v4, s[8:11], s28 offen  lds
    s_add_u32 m0, s5, s46
    s_nop 0
    buffer_load_dwordx4 v5, s[8:11], s29 offen  lds
    s_add_u32 m0, s6, s46
    s_nop 0
    buffer_load_dwordx4 v4, s[8:11], s30 offen  lds
    s_add_u32 m0, s7, s46
    s_nop 0
    buffer_load_dwordx4 v5, s[8:11], s31 offen  lds
    s_cmp_lg_u32 s47, 1
    s_cbranch_scc1 L_ldw_m
    s_waitcnt vmcnt(12)
    s_barrier
L_ldw_m:
    s_add_u32 m0, s16, s46
    s_nop 0
    buffer_load_dwordx4 v4, s[8:11], s40 offen  lds
    s_add_u32 m0, s17, s46
    s_nop 0
    buffer_load_dwordx4 v5, s[8:11], s41 offen  lds
    s_add_u32 m0, s18, s46
    s_nop 0
    buffer_load_dwordx4 v4, s[8:11], s33 offen  lds
    s_add_u32 m0, s19, s46
    s_nop 0
    buffer_load_dwordx4 v5, s[8:11], s43 offen  lds
    s_add_u32 s45, s45, 1
    s_cmp_eq_u32 s45, 10
    s_cselect_b32 s45, 0, s45
    s_cselect_b32 s42, s49, s48
    s_mov_b32 s70, s48
    s_mov_b32 s48, s51
    s_mov_b32 s51, s70
    v_add_u32 v4, s42, v4
    v_add_u32 v5, s42, v5
    s_add_u32 s46, s46, 49152
    s_cmp_eq_u32 s46, 147456
    s_cselect_b32 s46, 0, s46
    s_cmp_lt_u32 s47, 2
    s_cbranch_scc1 L_ldw_nx
    s_waitcnt vmcnt(16)
    s_barrier
    s_cmp_eq_u32 s47, 9
    s_cbranch_scc1 L_p2last
L_ldw_nx:
    s_add_u32 s47, s47, 1
    s_branch L_ldw_l
L_ldc:
    v_lshrrev_b32 v1, 3, v0
    v_and_b32 v2, 7, v0
    v_lshrrev_b32 v3, 1, v1
    v_xor_b32 v2, v2, v3
    v_lshlrev_b32 v2, 4, v2
    s_min_u32 s72, s30, 1
    s_add_u32 s45, s30, s72
    s_mul_i32 s72, s31, 3
    s_add_u32 s45, s45, s72
    s_cmp_ge_u32 s45, 5
    s_cselect_b32 s72, 5, 0
    s_sub_u32 s45, s45, s72
    s_lshr_b32 s70, s30, 1
    s_mul_i32 s70, s70, 160
    s_and_b32 s71, s30, 1
    s_add_u32 s70, s70, s71
    s_add_u32 s70, s70, 1
    v_lshlrev_b32 v1, 1, v1
    v_add_u32 v1, s70, v1
    v_mul_u32_u24 v3, 1280, v1
    v_add_u32 v2, v2, v3
    s_and_b32 s70, s32, 1
    s_lshl_b32 s70, s70, 6
    v_xor_b32 v4, s70, v2
    v_xor_b32 v5, 64, v4
    s_lshl_b32 s70, s32, 10
    s_lshl_b32 s71, s44, 14
    s_or_b32 s20, s70, s71
    s_mul_i32 s66, s70, 20
    s_add_u32 s70, s70, 1024
    s_cmp_eq_u32 s70, 10240
    s_cselect_b32 s70, 0, s70
    s_or_b32 s21, s70, s71
    s_mul_i32 s67, s70, 20
    s_add_u32 s70, s70, 1024
    s_cmp_eq_u32 s70, 10240
    s_cselect_b32 s70, 0, s70
    s_or_b32 s22, s70, s71
    s_mul_i32 s68, s70, 20
    s_add_u32 s70, s70, 1024
    s_cmp_eq_u32 s70, 10240
    s_cselect_b32 s70, 0, s70
    s_or_b32 s23, s70, s71
    s_mul_i32 s69, s70, 20
    s_add_u32 s70, s70, 1024
    s_cmp_eq_u32 s70, 10240
    s_cselect_b32 s70, 0, s70
    s_or_b32 s24, s70, s71
    s_mul_i32 s76, s70, 20
    s_add_u32 s70, s70, 1024
    s_cmp_eq_u32 s70, 10240
    s_cselect_b32 s70, 0, s70
    s_or_b32 s25, s70, s71
    s_mul_i32 s77, s70, 20
    s_add_u32 s70, s70, 1024
    s_cmp_eq_u32 s70, 10240
    s_cselect_b32 s70, 0, s70
    s_or_b32 s26, s70, s71
    s_mul_i32 s78, s70, 20
    s_add_u32 s70, s70, 1024
    s_cmp_eq_u32 s70, 10240
    s_cselect_b32 s70, 0, s70
    s_or_b32 s27, s70, s71
    s_mul_i32 s79, s70, 20
    s_add_u32 s70, s70, 1024
    s_cmp_eq_u32 s70, 10240
    s_cselect_b32 s70, 0, s70
    s_or_b32 s4, s70, s71
    s_mul_i32 s28, s70, 20
    s_add_u32 s70, s70, 1024
    s_cmp_eq_u32 s70, 10240
    s_cselect_b32 s70, 0, s70
    s_or_b32 s5, s70, s71
    s_mul_i32 s29, s70, 20
    s_cmp_eq_u32 s44, 1
    s_waitcnt lgkmcnt(0)
    s_cselect_b32 s8, s62, s60
    s_cselect_b32 s9, s63, s61
    s_mov_b32 s10, 819200
    s_mov_b32 s11, 0x00020000
    s_lshl_b32 s42, s45, 7
    v_add_u32 v4, s42, v4
    v_add_u32 v5, s42, v5
    s_mov_b32 s46, 49152
    s_mov_b32 s47, 1
L_ldcl:
    s_add_u32 m0, s20, s46
    s_nop 0
    buffer_load_dwordx4 v4, s[8:11], s66 offen lds
    s_add_u32 m0, s21, s46
    s_nop 0
    buffer_load_dwordx4 v5, s[8:11], s67 offen lds
    s_add_u32 m0, s22, s46
    s_nop 0
    buffer_load_dwordx4 v4, s[8:11], s68 offen lds
    s_add_u32 m0, s23, s46
    s_nop 0
    buffer_load_dwordx4 v5, s[8:11], s69 offen lds
    s_add_u32 m0, s24, s46
    s_nop 0
    buffer_load_dwordx4 v4, s[8:11], s76 offen lds
    s_add_u32 m0, s25, s46
    s_nop 0
    buffer_load_dwordx4 v5, s[8:11], s77 offen lds
    s_add_u32 m0, s26, s46
    s_nop 0
    buffer_load_dwordx4 v4, s[8:11], s78 offen lds
    s_add_u32 m0, s27, s46
    s_nop 0
    buffer_load_dwordx4 v5, s[8:11], s79 offen lds
    s_add_u32 m0, s4, s46
    s_nop 0
    buffer_load_dwordx4 v4, s[8:11], s28 offen lds
    s_add_u32 m0, s5, s46
    s_nop 0
    buffer_load_dwordx4 v5, s[8:11], s29 offen lds
    s_add_u32 s45, s45, 1
    s_cmp_eq_u32 s45, 5
    s_cselect_b32 s45, 0, s45
    s_movk_i32 s42, 128
    s_cselect_b32 s42, -512, s42
    v_add_u32 v4, s42, v4
    v_add_u32 v5, s42, v5
    s_sub_u32 s46, s46, 49152
    s_cselect_b32 s46, 98304, s46
    s_barrier
    s_cmp_eq_u32 s47, 9
    s_cbranch_scc1 L_p2last
    s_waitcnt vmcnt(0)
    s_barrier
    s_add_u32 s47, s47, 2
    s_branch L_ldcl
L_p2last:
    s_waitcnt vmcnt(0)
    v_mov_b32 v2, 149504
    v_mov_b32 v3, 1
    s_waitcnt lgkmcnt(0)
    s_mov_b64 exec, 1
    ds_add_u32 v2, v3 offset:12
    s_mov_b64 exec, -1
    v_mov_b32 v2, 149536
    ds_read_b32 v2, v2
    s_waitcnt lgkmcnt(0)
    v_readfirstlane_b32 s43, v2
    v_lshlrev_b32 v1, 4, v0
    s_mov_b32 s12, s58
    s_mov_b32 s13, s59
    s_mov_b32 s14, 16777216
    s_mov_b32 s15, 0x00020000
    s_mul_i32 s70, s38, 48
    s_mul_i32 s71, s44, 12
    s_add_u32 s70, s70, s71
    s_mul_i32 s70, s70, 5120
    s_add_u32 s70, s70, 6291456
    s_mul_i32 s73, s44, 10240
    s_mov_b32 s16, s54
    s_mov_b32 s17, s55
    s_mov_b32 s18, 2621440
    s_mov_b32 s19, 0x00020000
L_p2join:
    s_add_u32 s72, s39, 0
    s_cmp_ge_u32 s72, 6
    s_cselect_b32 s71, 6, 0
    s_sub_u32 s72, s72, s71
    s_lshl_b32 s72, s72, 1
    s_add_u32 s72, s72, 1
    s_mul_i32 s72, s72, 5120
    s_add_u32 s72, s72, s70
    buffer_load_dwordx4 v[56:59], v1, s[12:15], s72 offen offset:0 sc1
    buffer_load_dwordx4 v[60:63], v1, s[12:15], s72 offen offset:1024 sc1
    buffer_load_dwordx4 v[64:67], v1, s[12:15], s72 offen offset:2048 sc1
    buffer_load_dwordx4 v[68:71], v1, s[12:15], s72 offen offset:3072 sc1
    s_add_u32 s72, s72, 4096
    buffer_load_dwordx4 v[72:75], v1, s[12:15], s72 offen offset:0 sc1
    s_add_u32 s72, s39, 1
    s_cmp_ge_u32 s72, 6
    s_cselect_b32 s71, 6, 0
    s_sub_u32 s72, s72, s71
    s_lshl_b32 s72, s72, 1
    s_add_u32 s72, s72, 1
    s_mul_i32 s72, s72, 5120
    s_add_u32 s72, s72, s70
    buffer_load_dwordx4 v[76:79], v1, s[12:15], s72 offen offset:0 sc1
    buffer_load_dwordx4 v[80:83], v1, s[12:15], s72 offen offset:1024 sc1
    buffer_load_dwordx4 v[84:87], v1, s[12:15], s72 offen offset:2048 sc1
    buffer_load_dwordx4 v[88:91], v1, s[12:15], s72 offen offset:3072 sc1
    s_add_u32 s72, s72, 4096
    buffer_load_dwordx4 v[92:95], v1, s[12:15], s72 offen offset:0 sc1
    s_add_u32 s72, s39, 2
    s_cmp_ge_u32 s72, 6
    s_cselect_b32 s71, 6, 0
    s_sub_u32 s72, s72, s71
    s_lshl_b32 s72, s72, 1
    s_add_u32 s72, s72, 1
    s_mul_i32 s72, s72, 5120
    s_add_u32 s72, s72, s70
    buffer_load_dwordx4 v[96:99], v1, s[12:15], s72 offen offset:0 sc1
    buffer_load_dwordx4 v[100:103], v1, s[12:15], s72 offen offset:1024 sc1
    buffer_load_dwordx4 v[104:107], v1, s[12:15], s72 offen offset:2048 sc1
    buffer_load_dwordx4 v[108:111], v1, s[12:15], s72 offen offset:3072 sc1
    s_add_u32 s72, s72, 4096
    buffer_load_dwordx4 v[112:115], v1, s[12:15], s72 offen offset:0 sc1
    s_add_u32 s72, s39, 3
    s_cmp_ge_u32 s72, 6
    s_cselect_b32 s71, 6, 0
    s_sub_u32 s72, s72, s71
    s_lshl_b32 s72, s72, 1
    s_add_u32 s72, s72, 1
    s_mul_i32 s72, s72, 5120
    s_add_u32 s72, s72, s70
    buffer_load_dwordx4 v[116:119], v1, s[12:15], s72 offen offset:0 sc1
    buffer_load_dwordx4 v[120:123], v1, s[12:15], s72 offen offset:1024 sc1
    buffer_load_dwordx4 v[124:127], v1, s[12:15], s72 offen offset:2048 sc1
    buffer_load_dwordx4 v[128:131], v1, s[12:15], s72 offen offset:3072 sc1
    s_add_u32 s72, s72, 4096
    buffer_load_dwordx4 v[132:135], v1, s[12:15], s72 offen offset:0 sc1
    s_add_u32 s72, s39, 4
    s_cmp_ge_u32 s72, 6
    s_cselect_b32 s71, 6, 0
    s_sub_u32 s72, s72, s71
    s_lshl_b32 s72, s72, 1
    s_add_u32 s72, s72, 1
    s_mul_i32 s72, s72, 5120
    s_add_u32 s72, s72, s70
    buffer_load_dwordx4 v[136:139], v1, s[12:15], s72 offen offset:0 sc1
    buffer_load_dwordx4 v[140:143], v1, s[12:15], s72 offen offset:1024 sc1
    buffer_load_dwordx4 v[144:147], v1, s[12:15], s72 offen offset:2048 sc1
    buffer_load_dwordx4 v[148:151], v1, s[12:15], s72 offen offset:3072 sc1
    s_add_u32 s72, s72, 4096
    buffer_load_dwordx4 v[152:155], v1, s[12:15], s72 offen offset:0 sc1
    s_add_u32 s72, s39, 5
    s_cmp_ge_u32 s72, 6
    s_cselect_b32 s71, 6, 0
    s_sub_u32 s72, s72, s71
    s_lshl_b32 s72, s72, 1
    s_add_u32 s72, s72, 1
    s_mul_i32 s72, s72, 5120
    s_add_u32 s72, s72, s70
    buffer_load_dwordx4 v[156:159], v1, s[12:15], s72 offen offset:0 sc1
    buffer_load_dwordx4 v[160:163], v1, s[12:15], s72 offen offset:1024 sc1
    buffer_load_dwordx4 v[164:167], v1, s[12:15], s72 offen offset:2048 sc1
    buffer_load_dwordx4 v[168:171], v1, s[12:15], s72 offen offset:3072 sc1
    s_add_u32 s72, s72, 4096
    buffer_load_dwordx4 v[172:175], v1, s[12:15], s72 offen offset:0 sc1
    s_cmp_eq_u32 s35, 0
    s_cbranch_scc1 L_p2ffn
    s_add_u32 s72, s39, 0
    s_cmp_ge_u32 s72, 6
    s_cselect_b32 s71, 6, 0
    s_sub_u32 s72, s72, s71
    s_lshl_b32 s72, s72, 1
    s_mul_i32 s72, s72, 5120
    s_add_u32 s72, s72, s70
    s_add_u32 m0, s73, 49152
    s_nop 0
    buffer_load_dwordx4 v1, s[12:15], s72 offen sc1 lds
    s_add_u32 m0, s73, 50176
    s_add_u32 s72, s72, 1024
    buffer_load_dwordx4 v1, s[12:15], s72 offen sc1 lds
    s_add_u32 m0, s73, 51200
    s_add_u32 s72, s72, 1024
    buffer_load_dwordx4 v1, s[12:15], s72 offen sc1 lds
    s_add_u32 m0, s73, 52224
    s_add_u32 s72, s72, 1024
    buffer_load_dwordx4 v1, s[12:15], s72 offen sc1 lds
    s_add_u32 m0, s73, 53248
    s_add_u32 s72, s72, 1024
    buffer_load_dwordx4 v1, s[12:15], s72 offen sc1 lds
    s_add_u32 s72, s39, 1
    s_cmp_ge_u32 s72, 6
    s_cselect_b32 s71, 6, 0
    s_sub_u32 s72, s72, s71
    s_lshl_b32 s72, s72, 1
    s_mul_i32 s72, s72, 5120
    s_add_u32 s72, s72, s70
    s_add_u32 m0, s73, 54272
    s_nop 0
    buffer_load_dwordx4 v1, s[12:15], s72 offen sc1 lds
    s_add_u32 m0, s73, 55296
    s_add_u32 s72, s72, 1024
    buffer_load_dwordx4 v1, s[12:15], s72 offen sc1 lds
    s_add_u32 m0, s73, 56320
    s_add_u32 s72, s72, 1024
    buffer_load_dwordx4 v1, s[12:15], s72 offen sc1 lds
    s_add_u32 m0, s73, 57344
    s_add_u32 s72, s72, 1024
    buffer_load_dwordx4 v1, s[12:15], s72 offen sc1 lds
    s_add_u32 m0, s73, 58368
    s_add_u32 s72, s72, 1024
    buffer_load_dwordx4 v1, s[12:15], s72 offen sc1 lds
    v_mov_b32 v4, 149504
    s_mov_b32 s100, 0
L_c8d:
    ds_read_b32 v5, v4 offset:16
    s_waitcnt lgkmcnt(0)
    v_readfirstlane_b32 s78, v5
    s_cmp_lt_u32 s78, 4
    s_cbranch_scc0 L_c8d_ok
    s_add_u32 s100, s100, 1
    s_cmp_lt_u32 s100, 8388608
    s_sleep 3
    s_cbranch_scc1 L_c8d
L_c8d_ok:
    s_add_u32 s72, s39, 2
    s_cmp_ge_u32 s72, 6
    s_cselect_b32 s71, 6, 0
    s_sub_u32 s72, s72, s71
    s_lshl_b32 s72, s72, 1
    s_mul_i32 s72, s72, 5120
    s_add_u32 s72, s72, s70
    s_add_u32 m0, s73, 98304
    s_nop 0
    buffer_load_dwordx4 v1, s[12:15], s72 offen sc1 lds
    s_add_u32 m0, s73, 99328
    s_add_u32 s72, s72, 1024
    buffer_load_dwordx4 v1, s[12:15], s72 offen sc1 lds
    s_add_u32 m0, s73, 100352
    s_add_u32 s72, s72, 1024
    buffer_load_dwordx4 v1, s[12:15], s72 offen sc1 lds
    s_add_u32 m0, s73, 101376
    s_add_u32 s72, s72, 1024
    buffer_load_dwordx4 v1, s[12:15], s72 offen sc1 lds
    s_add_u32 m0, s73, 102400
    s_add_u32 s72, s72, 1024
    buffer_load_dwordx4 v1, s[12:15], s72 offen sc1 lds
    s_add_u32 s72, s39, 3
    s_cmp_ge_u32 s72, 6
    s_cselect_b32 s71, 6, 0
    s_sub_u32 s72, s72, s71
    s_lshl_b32 s72, s72, 1
    s_mul_i32 s72, s72, 5120
    s_add_u32 s72, s72, s70
    s_add_u32 m0, s73, 103424
    s_nop 0
    buffer_load_dwordx4 v1, s[12:15], s72 offen sc1 lds
    s_add_u32 m0, s73, 104448
    s_add_u32 s72, s72, 1024
    buffer_load_dwordx4 v1, s[12:15], s72 offen sc1 lds
    s_add_u32 m0, s73, 105472
    s_add_u32 s72, s72, 1024
    buffer_load_dwordx4 v1, s[12:15], s72 offen sc1 lds
    s_add_u32 m0, s73, 106496
    s_add_u32 s72, s72, 1024
    buffer_load_dwordx4 v1, s[12:15], s72 offen sc1 lds
    s_add_u32 m0, s73, 107520
    s_add_u32 s72, s72, 1024
    buffer_load_dwordx4 v1, s[12:15], s72 offen sc1 lds
    s_branch L_p2d
L_p2ffn:
L_p2d:
    v_add_u32 v2, s73, v1
    v_add_u32 v3, 98304, v2
    v_min_u32 v4, 5, v0
    v_lshrrev_b32 v5, 1, v4
    v_and_b32 v4, 1, v4
    v_lshlrev_b32 v4, 2, v4
    v_lshl_add_u32 v6, v5, 4, v4
    s_lshl_b32 s76, s36, 8
    s_mul_i32 s77, s44, 48
    s_add_u32 s76, s76, s77
    s_lshl_b32 s77, s37, 3
    s_add_u32 s76, s76, s77
    s_add_u32 s76, s76, 11735040
    s_lshl_b32 s74, s36, 3
    s_lshl_b32 s75, s37, 2
    s_add_u32 s74, s74, s75
    s_mul_i32 s74, s74, 48
    s_mul_i32 s75, s44, 12
    s_add_u32 s74, s74, s75
    s_lshl_b32 s74, s74, 10
    v_mov_b32 v176, 0
    v_mov_b32 v177, 0
    v_mov_b32 v178, 0
    v_mov_b32 v179, 0
    v_mov_b32 v180, 0
    v_mov_b32 v181, 0
    v_mov_b32 v182, 0
    v_mov_b32 v183, 0
    v_mov_b32 v184, 0
    v_mov_b32 v185, 0
    v_mov_b32 v186, 0
    v_mov_b32 v187, 0
    v_mov_b32 v188, 0
    v_mov_b32 v189, 0
    v_mov_b32 v190, 0
    v_mov_b32 v191, 0
    v_mov_b32 v192, 0
    v_mov_b32 v193, 0
    v_mov_b32 v194, 0
    v_mov_b32 v195, 0
    v_mov_b32 v196, 0
    v_mov_b32 v197, 0
    v_mov_b32 v198, 0
    v_mov_b32 v199, 0
    v_mov_b32 v200, 0
    v_mov_b32 v201, 0
    v_mov_b32 v202, 0
    v_mov_b32 v203, 0
    v_mov_b32 v204, 0
    v_mov_b32 v205, 0
    v_mov_b32 v206, 0
    v_mov_b32 v207, 0
    v_mov_b32 v208, 0
    v_mov_b32 v209, 0
    v_mov_b32 v210, 0
    v_mov_b32 v211, 0
    v_mov_b32 v212, 0
    v_mov_b32 v213, 0
    v_mov_b32 v214, 0
    v_mov_b32 v215, 0
    v_mov_b32 v216, 0
    v_mov_b32 v217, 0
    v_mov_b32 v218, 0
    v_mov_b32 v219, 0
    v_mov_b32 v220, 0
    v_mov_b32 v221, 0
    v_mov_b32 v222, 0
    v_mov_b32 v223, 0
    v_mov_b32 v224, 0
    v_mov_b32 v225, 0
    v_mov_b32 v226, 0
    v_mov_b32 v227, 0
    v_mov_b32 v228, 0
    v_mov_b32 v229, 0
    v_mov_b32 v230, 0
    v_mov_b32 v231, 0
    v_mov_b32 v232, 0
    v_mov_b32 v233, 0
    v_mov_b32 v234, 0
    v_mov_b32 v235, 0
    v_mov_b32 v236, 0
    v_mov_b32 v237, 0
    v_mov_b32 v238, 0
    v_mov_b32 v239, 0
    v_mov_b32 v240, 0
    v_mov_b32 v241, 0
    v_mov_b32 v242, 0
    v_mov_b32 v243, 0
    v_mov_b32 v244, 0
    v_mov_b32 v245, 0
    v_mov_b32 v246, 0
    v_mov_b32 v247, 0
    v_mov_b32 v248, 0
    v_mov_b32 v249, 0
    v_mov_b32 v250, 0
    v_mov_b32 v251, 0
    v_mov_b32 v252, 0
    v_mov_b32 v253, 0
    v_mov_b32 v254, 0
    v_mov_b32 v255, 0
    s_barrier
    s_waitcnt vmcnt(0)
    s_mov_b32 s79, 0
    v_mov_b32 v4, 149504
    v_mov_b32 v5, 1
    ds_write_b32 v4, v5 offset:40
    s_add_u32 s72, s39, 0
    s_cmp_ge_u32 s72, 6
    s_cselect_b32 s71, 6, 0
    s_sub_u32 s72, s72, s71
    s_lshl_b32 s72, s72, 1
    s_add_u32 s72, s72, 1
    s_lshl_b32 s72, s72, 10
    s_add_u32 s72, s72, s74
    s_mov_b32 s66, s72
    buffer_load_dwordx4 v[8:11], v1, s[12:15], s72 offen sc1
    s_add_u32 s72, s72, 49152
    buffer_load_dwordx4 v[12:15], v1, s[12:15], s72 offen sc1
    s_add_u32 s72, s72, 49152
    buffer_load_dwordx4 v[16:19], v1, s[12:15], s72 offen sc1
    s_add_u32 s72, s72, 49152
    buffer_load_dwordx4 v[20:23], v1, s[12:15], s72 offen sc1
    s_add_u32 s72, s39, 1
    s_cmp_ge_u32 s72, 6
    s_cselect_b32 s71, 6, 0
    s_sub_u32 s72, s72, s71
    s_lshl_b32 s72, s72, 1
    s_add_u32 s72, s72, 1
    s_lshl_b32 s72, s72, 10
    s_add_u32 s72, s72, s74
    s_mov_b32 s67, s72
    buffer_load_dwordx4 v[24:27], v1, s[12:15], s72 offen sc1
    s_add_u32 s72, s72, 49152
    buffer_load_dwordx4 v[28:31], v1, s[12:15], s72 offen sc1
    s_add_u32 s72, s72, 49152
    buffer_load_dwordx4 v[32:35], v1, s[12:15], s72 offen sc1
    s_add_u32 s72, s72, 49152
    buffer_load_dwordx4 v[36:39], v1, s[12:15], s72 offen sc1
    s_add_u32 s72, s39, 2
    s_cmp_ge_u32 s72, 6
    s_cselect_b32 s71, 6, 0
    s_sub_u32 s72, s72, s71
    s_lshl_b32 s72, s72, 1
    s_add_u32 s72, s72, 1
    s_lshl_b32 s72, s72, 10
    s_add_u32 s72, s72, s74
    s_mov_b32 s68, s72
    buffer_load_dwordx4 v[40:43], v1, s[12:15], s72 offen sc1
    s_add_u32 s72, s72, 49152
    buffer_load_dwordx4 v[44:47], v1, s[12:15], s72 offen sc1
    s_add_u32 s72, s72, 49152
    buffer_load_dwordx4 v[48:51], v1, s[12:15], s72 offen sc1
    s_add_u32 s72, s72, 49152
    buffer_load_dwordx4 v[52:55], v1, s[12:15], s72 offen sc1
    s_add_u32 s72, s39, 3
    s_cmp_ge_u32 s72, 6
    s_cselect_b32 s71, 6, 0
    s_sub_u32 s72, s72, s71
    s_lshl_b32 s72, s72, 1
    s_add_u32 s72, s72, 1
    s_lshl_b32 s72, s72, 10
    s_add_u32 s72, s72, s74
    s_mov_b32 s69, s72
    s_waitcnt vmcnt(8)
L_hchk0:
    v_max_u32 v4, v8, v12
    v_max3_u32 v4, v16, v20, v4
    v_cmp_eq_u32 vcc, -1, v4
    s_cmp_lg_u64 vcc, 0
    s_cbranch_scc1 L_hretry0
L_hok0:
    v_mfma_f32_16x16x32_bf16 v[176:179], v[56:59], v[8:11], v[176:179]
    v_mfma_f32_16x16x32_bf16 v[192:195], v[60:63], v[8:11], v[192:195]
    v_mfma_f32_16x16x32_bf16 v[208:211], v[64:67], v[8:11], v[208:211]
    v_mfma_f32_16x16x32_bf16 v[224:227], v[68:71], v[8:11], v[224:227]
    v_mfma_f32_16x16x32_bf16 v[240:243], v[72:75], v[8:11], v[240:243]
    buffer_load_dwordx4 v[8:11], v1, s[12:15], s72 offen sc1
    v_mfma_f32_16x16x32_bf16 v[244:247], v[72:75], v[12:15], v[244:247]
    v_mfma_f32_16x16x32_bf16 v[228:231], v[68:71], v[12:15], v[228:231]
    v_mfma_f32_16x16x32_bf16 v[212:215], v[64:67], v[12:15], v[212:215]
    v_mfma_f32_16x16x32_bf16 v[196:199], v[60:63], v[12:15], v[196:199]
    v_mfma_f32_16x16x32_bf16 v[180:183], v[56:59], v[12:15], v[180:183]
    s_add_u32 s72, s72, 49152
    buffer_load_dwordx4 v[12:15], v1, s[12:15], s72 offen sc1
    v_mfma_f32_16x16x32_bf16 v[184:187], v[56:59], v[16:19], v[184:187]
    v_mfma_f32_16x16x32_bf16 v[200:203], v[60:63], v[16:19], v[200:203]
    v_mfma_f32_16x16x32_bf16 v[216:219], v[64:67], v[16:19], v[216:219]
    v_mfma_f32_16x16x32_bf16 v[232:235], v[68:71], v[16:19], v[232:235]
    v_mfma_f32_16x16x32_bf16 v[248:251], v[72:75], v[16:19], v[248:251]
    s_add_u32 s72, s72, 49152
    buffer_load_dwordx4 v[16:19], v1, s[12:15], s72 offen sc1
    v_mfma_f32_16x16x32_bf16 v[252:255], v[72:75], v[20:23], v[252:255]
    v_mfma_f32_16x16x32_bf16 v[236:239], v[68:71], v[20:23], v[236:239]
    v_mfma_f32_16x16x32_bf16 v[220:223], v[64:67], v[20:23], v[220:223]
    v_mfma_f32_16x16x32_bf16 v[204:207], v[60:63], v[20:23], v[204:207]
    v_mfma_f32_16x16x32_bf16 v[188:191], v[56:59], v[20:23], v[188:191]
    s_add_u32 s72, s72, 49152
    buffer_load_dwordx4 v[20:23], v1, s[12:15], s72 offen sc1
    s_add_u32 s72, s39, 4
    s_cmp_ge_u32 s72, 6
    s_cselect_b32 s71, 6, 0
    s_sub_u32 s72, s72, s71
    s_lshl_b32 s72, s72, 1
    s_add_u32 s72, s72, 1
    s_lshl_b32 s72, s72, 10
    s_add_u32 s72, s72, s74
    s_mov_b32 s66, s72
    s_waitcnt vmcnt(8)
L_hchk1:
    v_max_u32 v4, v24, v28
    v_max3_u32 v4, v32, v36, v4
    v_cmp_eq_u32 vcc, -1, v4
    s_cmp_lg_u64 vcc, 0
    s_cbranch_scc1 L_hretry1
L_hok1:
    v_mfma_f32_16x16x32_bf16 v[176:179], v[76:79], v[24:27], v[176:179]
    v_mfma_f32_16x16x32_bf16 v[192:195], v[80:83], v[24:27], v[192:195]
    v_mfma_f32_16x16x32_bf16 v[208:211], v[84:87], v[24:27], v[208:211]
    v_mfma_f32_16x16x32_bf16 v[224:227], v[88:91], v[24:27], v[224:227]
    v_mfma_f32_16x16x32_bf16 v[240:243], v[92:95], v[24:27], v[240:243]
    buffer_load_dwordx4 v[24:27], v1, s[12:15], s72 offen sc1
    v_mfma_f32_16x16x32_bf16 v[244:247], v[92:95], v[28:31], v[244:247]
    v_mfma_f32_16x16x32_bf16 v[228:231], v[88:91], v[28:31], v[228:231]
    v_mfma_f32_16x16x32_bf16 v[212:215], v[84:87], v[28:31], v[212:215]
    v_mfma_f32_16x16x32_bf16 v[196:199], v[80:83], v[28:31], v[196:199]
    v_mfma_f32_16x16x32_bf16 v[180:183], v[76:79], v[28:31], v[180:183]
    s_add_u32 s72, s72, 49152
    buffer_load_dwordx4 v[28:31], v1, s[12:15], s72 offen sc1
    v_mfma_f32_16x16x32_bf16 v[184:187], v[76:79], v[32:35], v[184:187]
    v_mfma_f32_16x16x32_bf16 v[200:203], v[80:83], v[32:35], v[200:203]
    v_mfma_f32_16x16x32_bf16 v[216:219], v[84:87], v[32:35], v[216:219]
    v_mfma_f32_16x16x32_bf16 v[232:235], v[88:91], v[32:35], v[232:235]
    v_mfma_f32_16x16x32_bf16 v[248:251], v[92:95], v[32:35], v[248:251]
    s_add_u32 s72, s72, 49152
    buffer_load_dwordx4 v[32:35], v1, s[12:15], s72 offen sc1
    v_mfma_f32_16x16x32_bf16 v[252:255], v[92:95], v[36:39], v[252:255]
    v_mfma_f32_16x16x32_bf16 v[236:239], v[88:91], v[36:39], v[236:239]
    v_mfma_f32_16x16x32_bf16 v[220:223], v[84:87], v[36:39], v[220:223]
    v_mfma_f32_16x16x32_bf16 v[204:207], v[80:83], v[36:39], v[204:207]
    v_mfma_f32_16x16x32_bf16 v[188:191], v[76:79], v[36:39], v[188:191]
    s_add_u32 s72, s72, 49152
    buffer_load_dwordx4 v[36:39], v1, s[12:15], s72 offen sc1
    s_add_u32 s72, s39, 5
    s_cmp_ge_u32 s72, 6
    s_cselect_b32 s71, 6, 0
    s_sub_u32 s72, s72, s71
    s_lshl_b32 s72, s72, 1
    s_add_u32 s72, s72, 1
    s_lshl_b32 s72, s72, 10
    s_add_u32 s72, s72, s74
    s_mov_b32 s67, s72
    s_waitcnt vmcnt(8)
L_hchk2:
    v_max_u32 v4, v40, v44
    v_max3_u32 v4, v48, v52, v4
    v_cmp_eq_u32 vcc, -1, v4
    s_cmp_lg_u64 vcc, 0
    s_cbranch_scc1 L_hretry2
L_hok2:
    v_mfma_f32_16x16x32_bf16 v[176:179], v[96:99], v[40:43], v[176:179]
    v_mfma_f32_16x16x32_bf16 v[192:195], v[100:103], v[40:43], v[192:195]
    v_mfma_f32_16x16x32_bf16 v[208:211], v[104:107], v[40:43], v[208:211]
    v_mfma_f32_16x16x32_bf16 v[224:227], v[108:111], v[40:43], v[224:227]
    v_mfma_f32_16x16x32_bf16 v[240:243], v[112:115], v[40:43], v[240:243]
    buffer_load_dwordx4 v[40:43], v1, s[12:15], s72 offen sc1
    v_mfma_f32_16x16x32_bf16 v[244:247], v[112:115], v[44:47], v[244:247]
    v_mfma_f32_16x16x32_bf16 v[228:231], v[108:111], v[44:47], v[228:231]
    v_mfma_f32_16x16x32_bf16 v[212:215], v[104:107], v[44:47], v[212:215]
    v_mfma_f32_16x16x32_bf16 v[196:199], v[100:103], v[44:47], v[196:199]
    v_mfma_f32_16x16x32_bf16 v[180:183], v[96:99], v[44:47], v[180:183]
    s_add_u32 s72, s72, 49152
    buffer_load_dwordx4 v[44:47], v1, s[12:15], s72 offen sc1
    v_mfma_f32_16x16x32_bf16 v[184:187], v[96:99], v[48:51], v[184:187]
    v_mfma_f32_16x16x32_bf16 v[200:203], v[100:103], v[48:51], v[200:203]
    v_mfma_f32_16x16x32_bf16 v[216:219], v[104:107], v[48:51], v[216:219]
    v_mfma_f32_16x16x32_bf16 v[232:235], v[108:111], v[48:51], v[232:235]
    v_mfma_f32_16x16x32_bf16 v[248:251], v[112:115], v[48:51], v[248:251]
    s_add_u32 s72, s72, 49152
    buffer_load_dwordx4 v[48:51], v1, s[12:15], s72 offen sc1
    v_mfma_f32_16x16x32_bf16 v[252:255], v[112:115], v[52:55], v[252:255]
    v_mfma_f32_16x16x32_bf16 v[236:239], v[108:111], v[52:55], v[236:239]
    v_mfma_f32_16x16x32_bf16 v[220:223], v[104:107], v[52:55], v[220:223]
    v_mfma_f32_16x16x32_bf16 v[204:207], v[100:103], v[52:55], v[204:207]
    v_mfma_f32_16x16x32_bf16 v[188:191], v[96:99], v[52:55], v[188:191]
    s_add_u32 s72, s72, 49152
    buffer_load_dwordx4 v[52:55], v1, s[12:15], s72 offen sc1
    s_add_u32 s72, s39, 0
    s_cmp_ge_u32 s72, 6
    s_cselect_b32 s71, 6, 0
    s_sub_u32 s72, s72, s71
    s_lshl_b32 s72, s72, 1
    s_lshl_b32 s72, s72, 10
    s_add_u32 s72, s72, s74
    s_mov_b32 s68, s72
    s_waitcnt vmcnt(8)
L_hchk3:
    v_max_u32 v4, v8, v12
    v_max3_u32 v4, v16, v20, v4
    v_cmp_eq_u32 vcc, -1, v4
    s_cmp_lg_u64 vcc, 0
    s_cbranch_scc1 L_hretry3
L_hok3:
    v_mfma_f32_16x16x32_bf16 v[176:179], v[116:119], v[8:11], v[176:179]
    v_mfma_f32_16x16x32_bf16 v[192:195], v[120:123], v[8:11], v[192:195]
    v_mfma_f32_16x16x32_bf16 v[208:211], v[124:127], v[8:11], v[208:211]
    v_mfma_f32_16x16x32_bf16 v[224:227], v[128:131], v[8:11], v[224:227]
    v_mfma_f32_16x16x32_bf16 v[240:243], v[132:135], v[8:11], v[240:243]
    buffer_load_dwordx4 v[8:11], v1, s[12:15], s72 offen sc1
    v_mfma_f32_16x16x32_bf16 v[244:247], v[132:135], v[12:15], v[244:247]
    v_mfma_f32_16x16x32_bf16 v[228:231], v[128:131], v[12:15], v[228:231]
    v_mfma_f32_16x16x32_bf16 v[212:215], v[124:127], v[12:15], v[212:215]
    v_mfma_f32_16x16x32_bf16 v[196:199], v[120:123], v[12:15], v[196:199]
    v_mfma_f32_16x16x32_bf16 v[180:183], v[116:119], v[12:15], v[180:183]
    s_add_u32 s72, s72, 49152
    buffer_load_dwordx4 v[12:15], v1, s[12:15], s72 offen sc1
    v_mfma_f32_16x16x32_bf16 v[184:187], v[116:119], v[16:19], v[184:187]
    v_mfma_f32_16x16x32_bf16 v[200:203], v[120:123], v[16:19], v[200:203]
    v_mfma_f32_16x16x32_bf16 v[216:219], v[124:127], v[16:19], v[216:219]
    v_mfma_f32_16x16x32_bf16 v[232:235], v[128:131], v[16:19], v[232:235]
    v_mfma_f32_16x16x32_bf16 v[248:251], v[132:135], v[16:19], v[248:251]
    s_add_u32 s72, s72, 49152
    buffer_load_dwordx4 v[16:19], v1, s[12:15], s72 offen sc1
    v_mfma_f32_16x16x32_bf16 v[252:255], v[132:135], v[20:23], v[252:255]
    v_mfma_f32_16x16x32_bf16 v[236:239], v[128:131], v[20:23], v[236:239]
    v_mfma_f32_16x16x32_bf16 v[220:223], v[124:127], v[20:23], v[220:223]
    v_mfma_f32_16x16x32_bf16 v[204:207], v[120:123], v[20:23], v[204:207]
    v_mfma_f32_16x16x32_bf16 v[188:191], v[116:119], v[20:23], v[188:191]
    s_add_u32 s72, s72, 49152
    buffer_load_dwordx4 v[20:23], v1, s[12:15], s72 offen sc1
    v_mov_b32 v4, 149504
    s_mov_b32 s100, 0
L_lw:
    ds_read_b32 v5, v4 offset:36
    s_waitcnt lgkmcnt(0)
    v_readfirstlane_b32 s78, v5
    s_cmp_lt_u32 s78, 4
    s_cbranch_scc0 L_lw_ok
    s_add_u32 s100, s100, 1
    s_cmp_lt_u32 s100, 8388608
    s_sleep 3
    s_cbranch_scc1 L_lw
L_lw_ok:
    s_add_u32 s72, s39, 1
    s_cmp_ge_u32 s72, 6
    s_cselect_b32 s71, 6, 0
    s_sub_u32 s72, s72, s71
    s_lshl_b32 s72, s72, 1
    s_lshl_b32 s72, s72, 10
    s_add_u32 s72, s72, s74
    s_mov_b32 s69, s72
    s_waitcnt vmcnt(8)
L_hchk4:
    v_max_u32 v4, v24, v28
    v_max3_u32 v4, v32, v36, v4
    v_cmp_eq_u32 vcc, -1, v4
    s_cmp_lg_u64 vcc, 0
    s_cbranch_scc1 L_hretry4
L_hok4:
    v_mfma_f32_16x16x32_bf16 v[176:179], v[136:139], v[24:27], v[176:179]
    ds_read_b128 v[56:59], v2 offset:49152
    v_mfma_f32_16x16x32_bf16 v[192:195], v[140:143], v[24:27], v[192:195]
    ds_read_b128 v[60:63], v2 offset:50176
    v_mfma_f32_16x16x32_bf16 v[208:211], v[144:147], v[24:27], v[208:211]
    ds_read_b128 v[64:67], v2 offset:51200
    v_mfma_f32_16x16x32_bf16 v[224:227], v[148:151], v[24:27], v[224:227]
    ds_read_b128 v[68:71], v2 offset:52224
    v_mfma_f32_16x16x32_bf16 v[240:243], v[152:155], v[24:27], v[240:243]
    ds_read_b128 v[72:75], v2 offset:53248
    buffer_load_dwordx4 v[24:27], v1, s[12:15], s72 offen sc1
    v_mfma_f32_16x16x32_bf16 v[244:247], v[152:155], v[28:31], v[244:247]
    v_mfma_f32_16x16x32_bf16 v[228:231], v[148:151], v[28:31], v[228:231]
    v_mfma_f32_16x16x32_bf16 v[212:215], v[144:147], v[28:31], v[212:215]
    v_mfma_f32_16x16x32_bf16 v[196:199], v[140:143], v[28:31], v[196:199]
    v_mfma_f32_16x16x32_bf16 v[180:183], v[136:139], v[28:31], v[180:183]
    s_add_u32 s72, s72, 49152
    buffer_load_dwordx4 v[28:31], v1, s[12:15], s72 offen sc1
    v_mfma_f32_16x16x32_bf16 v[184:187], v[136:139], v[32:35], v[184:187]
    v_mfma_f32_16x16x32_bf16 v[200:203], v[140:143], v[32:35], v[200:203]
    v_mfma_f32_16x16x32_bf16 v[216:219], v[144:147], v[32:35], v[216:219]
    v_mfma_f32_16x16x32_bf16 v[232:235], v[148:151], v[32:35], v[232:235]
    v_mfma_f32_16x16x32_bf16 v[248:251], v[152:155], v[32:35], v[248:251]
    s_add_u32 s72, s72, 49152
    buffer_load_dwordx4 v[32:35], v1, s[12:15], s72 offen sc1
    v_mfma_f32_16x16x32_bf16 v[252:255], v[152:155], v[36:39], v[252:255]
    v_mfma_f32_16x16x32_bf16 v[236:239], v[148:151], v[36:39], v[236:239]
    v_mfma_f32_16x16x32_bf16 v[220:223], v[144:147], v[36:39], v[220:223]
    v_mfma_f32_16x16x32_bf16 v[204:207], v[140:143], v[36:39], v[204:207]
    v_mfma_f32_16x16x32_bf16 v[188:191], v[136:139], v[36:39], v[188:191]
    s_add_u32 s72, s72, 49152
    buffer_load_dwordx4 v[36:39], v1, s[12:15], s72 offen sc1
    s_add_u32 s72, s39, 2
    s_cmp_ge_u32 s72, 6
    s_cselect_b32 s71, 6, 0
    s_sub_u32 s72, s72, s71
    s_lshl_b32 s72, s72, 1
    s_lshl_b32 s72, s72, 10
    s_add_u32 s72, s72, s74
    s_mov_b32 s66, s72
    s_waitcnt vmcnt(8)
L_hchk5:
    v_max_u32 v4, v40, v44
    v_max3_u32 v4, v48, v52, v4
    v_cmp_eq_u32 vcc, -1, v4
    s_cmp_lg_u64 vcc, 0
    s_cbranch_scc1 L_hretry5
L_hok5:
    v_mfma_f32_16x16x32_bf16 v[176:179], v[156:159], v[40:43], v[176:179]
    ds_read_b128 v[76:79], v2 offset:54272
    v_mfma_f32_16x16x32_bf16 v[192:195], v[160:163], v[40:43], v[192:195]
    ds_read_b128 v[80:83], v2 offset:55296
    v_mfma_f32_16x16x32_bf16 v[208:211], v[164:167], v[40:43], v[208:211]
    ds_read_b128 v[84:87], v2 offset:56320
    v_mfma_f32_16x16x32_bf16 v[224:227], v[168:171], v[40:43], v[224:227]
    ds_read_b128 v[88:91], v2 offset:57344
    v_mfma_f32_16x16x32_bf16 v[240:243], v[172:175], v[40:43], v[240:243]
    ds_read_b128 v[92:95], v2 offset:58368
    buffer_load_dwordx4 v[40:43], v1, s[12:15], s72 offen sc1
    v_mfma_f32_16x16x32_bf16 v[244:247], v[172:175], v[44:47], v[244:247]
    v_mfma_f32_16x16x32_bf16 v[228:231], v[168:171], v[44:47], v[228:231]
    v_mfma_f32_16x16x32_bf16 v[212:215], v[164:167], v[44:47], v[212:215]
    v_mfma_f32_16x16x32_bf16 v[196:199], v[160:163], v[44:47], v[196:199]
    v_mfma_f32_16x16x32_bf16 v[180:183], v[156:159], v[44:47], v[180:183]
    s_add_u32 s72, s72, 49152
    buffer_load_dwordx4 v[44:47], v1, s[12:15], s72 offen sc1
    v_mfma_f32_16x16x32_bf16 v[184:187], v[156:159], v[48:51], v[184:187]
    v_mfma_f32_16x16x32_bf16 v[200:203], v[160:163], v[48:51], v[200:203]
    v_mfma_f32_16x16x32_bf16 v[216:219], v[164:167], v[48:51], v[216:219]
    v_mfma_f32_16x16x32_bf16 v[232:235], v[168:171], v[48:51], v[232:235]
    v_mfma_f32_16x16x32_bf16 v[248:251], v[172:175], v[48:51], v[248:251]
    s_add_u32 s72, s72, 49152
    buffer_load_dwordx4 v[48:51], v1, s[12:15], s72 offen sc1
    v_mfma_f32_16x16x32_bf16 v[252:255], v[172:175], v[52:55], v[252:255]
    v_mfma_f32_16x16x32_bf16 v[236:239], v[168:171], v[52:55], v[236:239]
    v_mfma_f32_16x16x32_bf16 v[220:223], v[164:167], v[52:55], v[220:223]
    v_mfma_f32_16x16x32_bf16 v[204:207], v[160:163], v[52:55], v[204:207]
    v_mfma_f32_16x16x32_bf16 v[188:191], v[156:159], v[52:55], v[188:191]
    s_add_u32 s72, s72, 49152
    buffer_load_dwordx4 v[52:55], v1, s[12:15], s72 offen sc1
    s_add_u32 s72, s39, 3
    s_cmp_ge_u32 s72, 6
    s_cselect_b32 s71, 6, 0
    s_sub_u32 s72, s72, s71
    s_lshl_b32 s72, s72, 1
    s_lshl_b32 s72, s72, 10
    s_add_u32 s72, s72, s74
    s_mov_b32 s67, s72
    s_waitcnt vmcnt(8) lgkmcnt(0)
    v_mfma_f32_16x16x32_bf16 v[176:179], v[56:59], v[8:11], v[176:179]
    ds_read_b128 v[96:99], v3 offset:0
    v_mfma_f32_16x16x32_bf16 v[192:195], v[60:63], v[8:11], v[192:195]
    ds_read_b128 v[100:103], v3 offset:1024
    v_mfma_f32_16x16x32_bf16 v[208:211], v[64:67], v[8:11], v[208:211]
    ds_read_b128 v[104:107], v3 offset:2048
    v_mfma_f32_16x16x32_bf16 v[224:227], v[68:71], v[8:11], v[224:227]
    ds_read_b128 v[108:111], v3 offset:3072
    v_mfma_f32_16x16x32_bf16 v[240:243], v[72:75], v[8:11], v[240:243]
    ds_read_b128 v[112:115], v3 offset:4096
    buffer_load_dwordx4 v[8:11], v1, s[12:15], s72 offen sc1
    v_mfma_f32_16x16x32_bf16 v[244:247], v[72:75], v[12:15], v[244:247]
    v_mfma_f32_16x16x32_bf16 v[228:231], v[68:71], v[12:15], v[228:231]
    v_mfma_f32_16x16x32_bf16 v[212:215], v[64:67], v[12:15], v[212:215]
    v_mfma_f32_16x16x32_bf16 v[196:199], v[60:63], v[12:15], v[196:199]
    v_mfma_f32_16x16x32_bf16 v[180:183], v[56:59], v[12:15], v[180:183]
    s_add_u32 s72, s72, 49152
    buffer_load_dwordx4 v[12:15], v1, s[12:15], s72 offen sc1
    v_mfma_f32_16x16x32_bf16 v[184:187], v[56:59], v[16:19], v[184:187]
    v_mfma_f32_16x16x32_bf16 v[200:203], v[60:63], v[16:19], v[200:203]
    v_mfma_f32_16x16x32_bf16 v[216:219], v[64:67], v[16:19], v[216:219]
    v_mfma_f32_16x16x32_bf16 v[232:235], v[68:71], v[16:19], v[232:235]
    v_mfma_f32_16x16x32_bf16 v[248:251], v[72:75], v[16:19], v[248:251]
    s_add_u32 s72, s72, 49152
    buffer_load_dwordx4 v[16:19], v1, s[12:15], s72 offen sc1
    v_mfma_f32_16x16x32_bf16 v[252:255], v[72:75], v[20:23], v[252:255]
    v_mfma_f32_16x16x32_bf16 v[236:239], v[68:71], v[20:23], v[236:239]
    v_mfma_f32_16x16x32_bf16 v[220:223], v[64:67], v[20:23], v[220:223]
    v_mfma_f32_16x16x32_bf16 v[204:207], v[60:63], v[20:23], v[204:207]
    v_mfma_f32_16x16x32_bf16 v[188:191], v[56:59], v[20:23], v[188:191]
    s_add_u32 s72, s72, 49152
    buffer_load_dwordx4 v[20:23], v1, s[12:15], s72 offen sc1
    s_add_u32 s72, s39, 4
    s_cmp_ge_u32 s72, 6
    s_cselect_b32 s71, 6, 0
    s_sub_u32 s72, s72, s71
    s_lshl_b32 s72, s72, 1
    s_lshl_b32 s72, s72, 10
    s_add_u32 s72, s72, s74
    s_mov_b32 s68, s72
    s_waitcnt vmcnt(8) lgkmcnt(0)
    v_mfma_f32_16x16x32_bf16 v[176:179], v[76:79], v[24:27], v[176:179]
    ds_read_b128 v[116:119], v3 offset:5120
    v_mfma_f32_16x16x32_bf16 v[192:195], v[80:83], v[24:27], v[192:195]
    ds_read_b128 v[120:123], v3 offset:6144
    v_mfma_f32_16x16x32_bf16 v[208:211], v[84:87], v[24:27], v[208:211]
    ds_read_b128 v[124:127], v3 offset:7168
    v_mfma_f32_16x16x32_bf16 v[224:227], v[88:91], v[24:27], v[224:227]
    ds_read_b128 v[128:131], v3 offset:8192
    v_mfma_f32_16x16x32_bf16 v[240:243], v[92:95], v[24:27], v[240:243]
    ds_read_b128 v[132:135], v3 offset:9216
    buffer_load_dwordx4 v[24:27], v1, s[12:15], s72 offen sc1
    v_mfma_f32_16x16x32_bf16 v[244:247], v[92:95], v[28:31], v[244:247]
    v_mfma_f32_16x16x32_bf16 v[228:231], v[88:91], v[28:31], v[228:231]
    v_mfma_f32_16x16x32_bf16 v[212:215], v[84:87], v[28:31], v[212:215]
    v_mfma_f32_16x16x32_bf16 v[196:199], v[80:83], v[28:31], v[196:199]
    v_mfma_f32_16x16x32_bf16 v[180:183], v[76:79], v[28:31], v[180:183]
    s_add_u32 s72, s72, 49152
    buffer_load_dwordx4 v[28:31], v1, s[12:15], s72 offen sc1
    v_mfma_f32_16x16x32_bf16 v[184:187], v[76:79], v[32:35], v[184:187]
    v_mfma_f32_16x16x32_bf16 v[200:203], v[80:83], v[32:35], v[200:203]
    v_mfma_f32_16x16x32_bf16 v[216:219], v[84:87], v[32:35], v[216:219]
    v_mfma_f32_16x16x32_bf16 v[232:235], v[88:91], v[32:35], v[232:235]
    v_mfma_f32_16x16x32_bf16 v[248:251], v[92:95], v[32:35], v[248:251]
    s_add_u32 s72, s72, 49152
    buffer_load_dwordx4 v[32:35], v1, s[12:15], s72 offen sc1
    v_mfma_f32_16x16x32_bf16 v[252:255], v[92:95], v[36:39], v[252:255]
    v_mfma_f32_16x16x32_bf16 v[236:239], v[88:91], v[36:39], v[236:239]
    v_mfma_f32_16x16x32_bf16 v[220:223], v[84:87], v[36:39], v[220:223]
    v_mfma_f32_16x16x32_bf16 v[204:207], v[80:83], v[36:39], v[204:207]
    v_mfma_f32_16x16x32_bf16 v[188:191], v[76:79], v[36:39], v[188:191]
    s_add_u32 s72, s72, 49152
    buffer_load_dwordx4 v[36:39], v1, s[12:15], s72 offen sc1
    s_add_u32 s72, s39, 5
    s_cmp_ge_u32 s72, 6
    s_cselect_b32 s71, 6, 0
    s_sub_u32 s72, s72, s71
    s_lshl_b32 s72, s72, 1
    s_lshl_b32 s72, s72, 10
    s_add_u32 s72, s72, s74
    s_mov_b32 s69, s72
    s_waitcnt vmcnt(8) lgkmcnt(0)
    v_mfma_f32_16x16x32_bf16 v[176:179], v[96:99], v[40:43], v[176:179]
    ds_read_b128 v[136:139], v2 offset:0
    v_mfma_f32_16x16x32_bf16 v[192:195], v[100:103], v[40:43], v[192:195]
    ds_read_b128 v[140:143], v2 offset:1024
    v_mfma_f32_16x16x32_bf16 v[208:211], v[104:107], v[40:43], v[208:211]
    ds_read_b128 v[144:147], v2 offset:2048
    v_mfma_f32_16x16x32_bf16 v[224:227], v[108:111], v[40:43], v[224:227]
    ds_read_b128 v[148:151], v2 offset:3072
    v_mfma_f32_16x16x32_bf16 v[240:243], v[112:115], v[40:43], v[240:243]
    ds_read_b128 v[152:155], v2 offset:4096
    buffer_load_dwordx4 v[40:43], v1, s[12:15], s72 offen sc1
    v_mfma_f32_16x16x32_bf16 v[244:247], v[112:115], v[44:47], v[244:247]
    v_mfma_f32_16x16x32_bf16 v[228:231], v[108:111], v[44:47], v[228:231]
    v_mfma_f32_16x16x32_bf16 v[212:215], v[104:107], v[44:47], v[212:215]
    v_mfma_f32_16x16x32_bf16 v[196:199], v[100:103], v[44:47], v[196:199]
    v_mfma_f32_16x16x32_bf16 v[180:183], v[96:99], v[44:47], v[180:183]
    s_add_u32 s72, s72, 49152
    buffer_load_dwordx4 v[44:47], v1, s[12:15], s72 offen sc1
    v_mfma_f32_16x16x32_bf16 v[184:187], v[96:99], v[48:51], v[184:187]
    v_mfma_f32_16x16x32_bf16 v[200:203], v[100:103], v[48:51], v[200:203]
    v_mfma_f32_16x16x32_bf16 v[216:219], v[104:107], v[48:51], v[216:219]
    v_mfma_f32_16x16x32_bf16 v[232:235], v[108:111], v[48:51], v[232:235]
    v_mfma_f32_16x16x32_bf16 v[248:251], v[112:115], v[48:51], v[248:251]
    s_add_u32 s72, s72, 49152
    buffer_load_dwordx4 v[48:51], v1, s[12:15], s72 offen sc1
    v_mfma_f32_16x16x32_bf16 v[252:255], v[112:115], v[52:55], v[252:255]
    v_mfma_f32_16x16x32_bf16 v[236:239], v[108:111], v[52:55], v[236:239]
    v_mfma_f32_16x16x32_bf16 v[220:223], v[104:107], v[52:55], v[220:223]
    v_mfma_f32_16x16x32_bf16 v[204:207], v[100:103], v[52:55], v[204:207]
    v_mfma_f32_16x16x32_bf16 v[188:191], v[96:99], v[52:55], v[188:191]
    s_add_u32 s72, s72, 49152
    buffer_load_dwordx4 v[52:55], v1, s[12:15], s72 offen sc1
    s_waitcnt vmcnt(8) lgkmcnt(0)
    v_mfma_f32_16x16x32_bf16 v[176:179], v[116:119], v[8:11], v[176:179]
    ds_read_b128 v[156:159], v2 offset:5120
    v_mfma_f32_16x16x32_bf16 v[192:195], v[120:123], v[8:11], v[192:195]
    ds_read_b128 v[160:163], v2 offset:6144
    v_mfma_f32_16x16x32_bf16 v[208:211], v[124:127], v[8:11], v[208:211]
    ds_read_b128 v[164:167], v2 offset:7168
    v_mfma_f32_16x16x32_bf16 v[224:227], v[128:131], v[8:11], v[224:227]
    ds_read_b128 v[168:171], v2 offset:8192
    v_mfma_f32_16x16x32_bf16 v[240:243], v[132:135], v[8:11], v[240:243]
    ds_read_b128 v[172:175], v2 offset:9216
    v_mfma_f32_16x16x32_bf16 v[244:247], v[132:135], v[12:15], v[244:247]
    v_mfma_f32_16x16x32_bf16 v[228:231], v[128:131], v[12:15], v[228:231]
    v_mfma_f32_16x16x32_bf16 v[212:215], v[124:127], v[12:15], v[212:215]
    v_mfma_f32_16x16x32_bf16 v[196:199], v[120:123], v[12:15], v[196:199]
    v_mfma_f32_16x16x32_bf16 v[180:183], v[116:119], v[12:15], v[180:183]
    v_mfma_f32_16x16x32_bf16 v[184:187], v[116:119], v[16:19], v[184:187]
    v_mfma_f32_16x16x32_bf16 v[200:203], v[120:123], v[16:19], v[200:203]
    v_mfma_f32_16x16x32_bf16 v[216:219], v[124:127], v[16:19], v[216:219]
    v_mfma_f32_16x16x32_bf16 v[232:235], v[128:131], v[16:19], v[232:235]
    v_mfma_f32_16x16x32_bf16 v[248:251], v[132:135], v[16:19], v[248:251]
    v_mfma_f32_16x16x32_bf16 v[252:255], v[132:135], v[20:23], v[252:255]
    v_mfma_f32_16x16x32_bf16 v[236:239], v[128:131], v[20:23], v[236:239]
    v_mfma_f32_16x16x32_bf16 v[220:223], v[124:127], v[20:23], v[220:223]
    v_mfma_f32_16x16x32_bf16 v[204:207], v[120:123], v[20:23], v[204:207]
    v_mfma_f32_16x16x32_bf16 v[188:191], v[116:119], v[20:23], v[188:191]
    s_waitcnt vmcnt(4) lgkmcnt(0)
    v_mfma_f32_16x16x32_bf16 v[176:179], v[136:139], v[24:27], v[176:179]
    s_lshl_b32 s66, s3, 6
    s_add_u32 s66, s66, 0
    v_add_u32 v8, s66, v0
    v_mfma_f32_16x16x32_bf16 v[192:195], v[140:143], v[24:27], v[192:195]
    v_mul_u32_u24 v9, 6554, v8
    v_lshrrev_b32 v9, 16, v9
    v_mul_u32_u24 v11, 10, v9
    v_mfma_f32_16x16x32_bf16 v[208:211], v[144:147], v[24:27], v[208:211]
    v_sub_u32 v11, v8, v11
    v_lshrrev_b32 v12, 4, v9
    v_and_b32 v9, 15, v9
    v_mfma_f32_16x16x32_bf16 v[224:227], v[148:151], v[24:27], v[224:227]
    v_lshrrev_b32 v14, 1, v11
    v_mov_b32 v15, 49152
    v_mov_b32 v10, 40960
    v_mfma_f32_16x16x32_bf16 v[240:243], v[152:155], v[24:27], v[240:243]
    v_cmp_eq_u32 vcc, 1, v14
    v_mov_b32 v16, 53568
    v_mov_b32 v17, 90176
    v_mfma_f32_16x16x32_bf16 v[244:247], v[152:155], v[28:31], v[244:247]
    v_cndmask_b32 v15, v15, v16, vcc
    v_cndmask_b32 v10, v10, v17, vcc
    v_cmp_eq_u32 vcc, 2, v14
    v_mfma_f32_16x16x32_bf16 v[228:231], v[148:151], v[28:31], v[228:231]
    v_mov_b32 v16, 98432
    v_mov_b32 v17, 139392
    v_cndmask_b32 v15, v15, v16, vcc
    v_mfma_f32_16x16x32_bf16 v[212:215], v[144:147], v[28:31], v[212:215]
    v_cndmask_b32 v10, v10, v17, vcc
    v_cmp_eq_u32 vcc, 3, v14
    v_mov_b32 v16, 102848
    v_mfma_f32_16x16x32_bf16 v[196:199], v[140:143], v[28:31], v[196:199]
    v_mov_b32 v17, 151744
    v_cndmask_b32 v15, v15, v16, vcc
    v_cndmask_b32 v10, v10, v17, vcc
    v_mfma_f32_16x16x32_bf16 v[180:183], v[136:139], v[28:31], v[180:183]
    v_cmp_eq_u32 vcc, 4, v14
    v_mov_b32 v16, 0
    v_mov_b32 v17, 156160
    v_mfma_f32_16x16x32_bf16 v[184:187], v[136:139], v[32:35], v[184:187]
    v_cndmask_b32 v15, v15, v16, vcc
    v_cndmask_b32 v10, v10, v17, vcc
    v_and_b32 v13, 1, v11
    v_mfma_f32_16x16x32_bf16 v[200:203], v[140:143], v[32:35], v[200:203]
    v_mul_u32_u24 v8, 544, v13
    v_mul_u32_u24 v13, 1088, v12
    v_add_u32 v8, v8, v13
    v_mfma_f32_16x16x32_bf16 v[216:219], v[144:147], v[32:35], v[216:219]
    v_lshl_add_u32 v8, v9, 4, v8
    v_add_u32 v10, v10, v8
    v_add_u32 v8, v15, v8
    v_mfma_f32_16x16x32_bf16 v[232:235], v[148:151], v[32:35], v[232:235]
    v_lshrrev_b32 v13, 2, v9
    v_and_b32 v9, 3, v9
    v_lshl_add_u32 v9, v9, 2, v13
    v_mfma_f32_16x16x32_bf16 v[248:251], v[152:155], v[32:35], v[248:251]
    v_lshlrev_b32 v9, 3, v9
    v_add_u32 v9, v9, v12
    v_lshlrev_b32 v9, 4, v9
    v_mfma_f32_16x16x32_bf16 v[252:255], v[152:155], v[36:39], v[252:255]
    s_lshl_b32 s66, s37, 6
    s_add_u32 s66, s66, s36
    v_add_u32 v9, s66, v9
    v_mfma_f32_16x16x32_bf16 v[236:239], v[148:151], v[36:39], v[236:239]
    v_mul_u32_u24 v9, 1280, v9
    v_lshl_add_u32 v9, v11, 4, v9
    s_mul_i32 s66, s38, 160
    v_mfma_f32_16x16x32_bf16 v[220:223], v[144:147], v[36:39], v[220:223]
    v_add_u32 v9, s66, v9
    v_mfma_f32_16x16x32_bf16 v[204:207], v[140:143], v[36:39], v[204:207]
    v_mfma_f32_16x16x32_bf16 v[188:191], v[136:139], v[36:39], v[188:191]
    v_and_b32 v2, 15, v0
    v_lshrrev_b32 v4, 4, v0
    v_mul_u32_u24 v4, 272, v4
    v_lshl_add_u32 v2, v2, 4, v4
    v_add_u32 v2, s73, v2
    v_add_u32 v3, 98304, v2
    s_waitcnt vmcnt(0) lgkmcnt(0)
    v_mfma_f32_16x16x32_bf16 v[176:179], v[156:159], v[40:43], v[176:179]
    v_mfma_f32_16x16x32_bf16 v[192:195], v[160:163], v[40:43], v[192:195]
    v_mfma_f32_16x16x32_bf16 v[208:211], v[164:167], v[40:43], v[208:211]
    v_mfma_f32_16x16x32_bf16 v[224:227], v[168:171], v[40:43], v[224:227]
    v_mfma_f32_16x16x32_bf16 v[240:243], v[172:175], v[40:43], v[240:243]
    v_mfma_f32_16x16x32_bf16 v[244:247], v[172:175], v[44:47], v[244:247]
    v_mfma_f32_16x16x32_bf16 v[228:231], v[168:171], v[44:47], v[228:231]
    v_mfma_f32_16x16x32_bf16 v[212:215], v[164:167], v[44:47], v[212:215]
    v_mfma_f32_16x16x32_bf16 v[196:199], v[160:163], v[44:47], v[196:199]
    v_mfma_f32_16x16x32_bf16 v[180:183], v[156:159], v[44:47], v[180:183]
    v_mfma_f32_16x16x32_bf16 v[184:187], v[156:159], v[48:51], v[184:187]
    v_mfma_f32_16x16x32_bf16 v[200:203], v[160:163], v[48:51], v[200:203]
    v_mfma_f32_16x16x32_bf16 v[216:219], v[164:167], v[48:51], v[216:219]
    v_mfma_f32_16x16x32_bf16 v[232:235], v[168:171], v[48:51], v[232:235]
    v_mfma_f32_16x16x32_bf16 v[248:251], v[172:175], v[48:51], v[248:251]
    ds_write_b128 v2, v[176:179] offset:49152
    ds_write_b128 v2, v[192:195] offset:53568
    ds_write_b128 v3, v[208:211] offset:128
    ds_write_b128 v3, v[224:227] offset:4544
    ds_write_b128 v2, v[240:243] offset:0
    v_mfma_f32_16x16x32_bf16 v[252:255], v[172:175], v[52:55], v[252:255]
    v_mfma_f32_16x16x32_bf16 v[236:239], v[168:171], v[52:55], v[236:239]
    v_mfma_f32_16x16x32_bf16 v[220:223], v[164:167], v[52:55], v[220:223]
    v_mfma_f32_16x16x32_bf16 v[204:207], v[160:163], v[52:55], v[204:207]
    v_mfma_f32_16x16x32_bf16 v[188:191], v[156:159], v[52:55], v[188:191]
    ds_write_b128 v2, v[180:183] offset:50240
    ds_write_b128 v2, v[196:199] offset:54656
    ds_write_b128 v3, v[212:215] offset:1216
    ds_write_b128 v3, v[228:231] offset:5632
    ds_write_b128 v2, v[244:247] offset:1088
    ds_write_b128 v2, v[184:187] offset:51328
    ds_write_b128 v2, v[200:203] offset:55744
    ds_write_b128 v3, v[216:219] offset:2304
    ds_write_b128 v3, v[232:235] offset:6720
    ds_write_b128 v2, v[248:251] offset:2176
    s_nop 3
    ds_write_b128 v2, v[188:191] offset:52416
    ds_write_b128 v2, v[204:207] offset:56832
    ds_write_b128 v3, v[220:223] offset:3392
    ds_write_b128 v3, v[236:239] offset:7808
    ds_write_b128 v2, v[252:255] offset:3264
    s_waitcnt lgkmcnt(0)
    s_barrier
    ds_read_b128 v[56:59], v8 offset:0
    ds_read_b128 v[60:63], v8 offset:272
    ds_read_b128 v[64:67], v8 offset:10240
    ds_read_b128 v[68:71], v8 offset:10512
    ds_read_b128 v[72:75], v8 offset:20480
    ds_read_b128 v[76:79], v8 offset:20752
    ds_read_b128 v[80:83], v8 offset:30720
    ds_read_b128 v[84:87], v8 offset:30992
    ds_read_b128 v[88:91], v10 offset:0
    ds_read_b128 v[92:95], v10 offset:272
    s_waitcnt lgkmcnt(6)
    v_pk_add_f32 v[56:57], v[56:57], v[64:65]
    v_pk_add_f32 v[58:59], v[58:59], v[66:67]
    v_pk_add_f32 v[60:61], v[60:61], v[68:69]
    v_pk_add_f32 v[62:63], v[62:63], v[70:71]
    s_waitcnt lgkmcnt(4)
    v_pk_add_f32 v[56:57], v[56:57], v[72:73]
    v_pk_add_f32 v[58:59], v[58:59], v[74:75]
    v_pk_add_f32 v[60:61], v[60:61], v[76:77]
    v_pk_add_f32 v[62:63], v[62:63], v[78:79]
    s_waitcnt lgkmcnt(2)
    v_pk_add_f32 v[56:57], v[56:57], v[80:81]
    v_pk_add_f32 v[58:59], v[58:59], v[82:83]
    v_pk_add_f32 v[60:61], v[60:61], v[84:85]
    v_pk_add_f32 v[62:63], v[62:63], v[86:87]
    s_waitcnt lgkmcnt(0)
    v_pk_add_f32 v[56:57], v[56:57], v[88:89]
    v_pk_add_f32 v[58:59], v[58:59], v[90:91]
    v_pk_add_f32 v[60:61], v[60:61], v[92:93]
    v_pk_add_f32 v[62:63], v[62:63], v[94:95]
    v_cvt_pk_bf16_f32 v64, v56, v57
    v_cvt_pk_bf16_f32 v65, v58, v59
    v_cvt_pk_bf16_f32 v66, v60, v61
    v_cvt_pk_bf16_f32 v67, v62, v63
    buffer_store_dwordx4 v[64:67], v9, s[16:19], 0 offen sc1
    s_branch L_fin2
L_hretry0:
    s_add_u32 s79, s79, 1
    s_cmp_ge_u32 s79, 1048576
    s_cbranch_scc1 L_hok0
    s_sleep 4
    s_mov_b32 s77, s66
    buffer_load_dwordx4 v[8:11], v1, s[12:15], s77 offen sc1
    s_add_u32 s77, s77, 49152
    buffer_load_dwordx4 v[12:15], v1, s[12:15], s77 offen sc1
    s_add_u32 s77, s77, 49152
    buffer_load_dwordx4 v[16:19], v1, s[12:15], s77 offen sc1
    s_add_u32 s77, s77, 49152
    buffer_load_dwordx4 v[20:23], v1, s[12:15], s77 offen sc1
    s_waitcnt vmcnt(0)
    s_branch L_hchk0
L_hretry1:
    s_add_u32 s79, s79, 1
    s_cmp_ge_u32 s79, 1048576
    s_cbranch_scc1 L_hok1
    s_sleep 4
    s_mov_b32 s77, s67
    buffer_load_dwordx4 v[24:27], v1, s[12:15], s77 offen sc1
    s_add_u32 s77, s77, 49152
    buffer_load_dwordx4 v[28:31], v1, s[12:15], s77 offen sc1
    s_add_u32 s77, s77, 49152
    buffer_load_dwordx4 v[32:35], v1, s[12:15], s77 offen sc1
    s_add_u32 s77, s77, 49152
    buffer_load_dwordx4 v[36:39], v1, s[12:15], s77 offen sc1
    s_waitcnt vmcnt(0)
    s_branch L_hchk1
L_hretry2:
    s_add_u32 s79, s79, 1
    s_cmp_ge_u32 s79, 1048576
    s_cbranch_scc1 L_hok2
    s_sleep 4
    s_mov_b32 s77, s68
    buffer_load_dwordx4 v[40:43], v1, s[12:15], s77 offen sc1
    s_add_u32 s77, s77, 49152
    buffer_load_dwordx4 v[44:47], v1, s[12:15], s77 offen sc1
    s_add_u32 s77, s77, 49152
    buffer_load_dwordx4 v[48:51], v1, s[12:15], s77 offen sc1
    s_add_u32 s77, s77, 49152
    buffer_load_dwordx4 v[52:55], v1, s[12:15], s77 offen sc1
    s_waitcnt vmcnt(0)
    s_branch L_hchk2
L_hretry3:
    s_add_u32 s79, s79, 1
    s_cmp_ge_u32 s79, 1048576
    s_cbranch_scc1 L_hok3
    s_sleep 4
    s_mov_b32 s77, s69
    buffer_load_dwordx4 v[8:11], v1, s[12:15], s77 offen sc1
    s_add_u32 s77, s77, 49152
    buffer_load_dwordx4 v[12:15], v1, s[12:15], s77 offen sc1
    s_add_u32 s77, s77, 49152
    buffer_load_dwordx4 v[16:19], v1, s[12:15], s77 offen sc1
    s_add_u32 s77, s77, 49152
    buffer_load_dwordx4 v[20:23], v1, s[12:15], s77 offen sc1
    s_waitcnt vmcnt(0)
    s_branch L_hchk3
L_hretry4:
    s_add_u32 s79, s79, 1
    s_cmp_ge_u32 s79, 1048576
    s_cbranch_scc1 L_hok4
    s_sleep 4
    s_mov_b32 s77, s66
    buffer_load_dwordx4 v[24:27], v1, s[12:15], s77 offen sc1
    s_add_u32 s77, s77, 49152
    buffer_load_dwordx4 v[28:31], v1, s[12:15], s77 offen sc1
    s_add_u32 s77, s77, 49152
    buffer_load_dwordx4 v[32:35], v1, s[12:15], s77 offen sc1
    s_add_u32 s77, s77, 49152
    buffer_load_dwordx4 v[36:39], v1, s[12:15], s77 offen sc1
    s_waitcnt vmcnt(0)
    s_branch L_hchk4
L_hretry5:
    s_add_u32 s79, s79, 1
    s_cmp_ge_u32 s79, 1048576
    s_cbranch_scc1 L_hok5
    s_sleep 4
    s_mov_b32 s77, s67
    buffer_load_dwordx4 v[40:43], v1, s[12:15], s77 offen sc1
    s_add_u32 s77, s77, 49152
    buffer_load_dwordx4 v[44:47], v1, s[12:15], s77 offen sc1
    s_add_u32 s77, s77, 49152
    buffer_load_dwordx4 v[48:51], v1, s[12:15], s77 offen sc1
    s_add_u32 s77, s77, 49152
    buffer_load_dwordx4 v[52:55], v1, s[12:15], s77 offen sc1
    s_waitcnt vmcnt(0)
    s_branch L_hchk5
L_aux:
    s_waitcnt lgkmcnt(0)
    s_mov_b32 s12, s58
    s_mov_b32 s13, s59
    s_mov_b32 s14, 16777216
    s_mov_b32 s15, 0x00020000
    s_mov_b32 s4, s64
    s_mov_b32 s5, s65
    s_mov_b32 s6, 2621440
    s_mov_b32 s7, 0x00020000
    s_mov_b32 s16, s54
    s_mov_b32 s17, s55
    s_mov_b32 s18, 2621440
    s_mov_b32 s19, 0x00020000
    s_mov_b32 s20, s52
    s_mov_b32 s21, s53
    s_mov_b32 s22, 1966080
    s_mov_b32 s23, 0x00020000
    s_mov_b32 s24, s56
    s_mov_b32 s25, s57
    s_mov_b32 s26, 256
    s_mov_b32 s27, 0x00020000
    v_mov_b32 v1, 0
    v_mov_b32 v3, 149504
    s_mov_b64 exec, 1
    s_cmp_lg_u32 s2, 0
    s_cbranch_scc1 L_aux_n0
    s_memrealtime s[66:67]
    s_waitcnt lgkmcnt(0)
    s_or_b32 s66, s66, 1
    v_mov_b32 v2, s66
    buffer_store_dword v2, v1, s[24:27], 0 offen sc1
L_aux_n0:
    ds_write_b32 v3, v1 offset:0
    ds_write_b32 v3, v1 offset:4
    ds_write_b32 v3, v1 offset:8
    ds_write_b32 v3, v1 offset:12
    ds_write_b32 v3, v1 offset:16
    ds_write_b32 v3, v1 offset:20
    ds_write_b32 v3, v1 offset:24
    ds_write_b32 v3, v1 offset:28
    ds_write_b32 v3, v1 offset:32
    ds_write_b32 v3, v1 offset:36
    ds_write_b32 v3, v1 offset:40
    ds_write_b32 v3, v1 offset:44
    ds_write_b32 v3, v1 offset:48
    ds_write_b32 v3, v1 offset:52
    ds_write_b32 v3, v1 offset:56
    s_mov_b64 exec, -1
    s_getpc_b64 s[66:67]
L_pcref:
    s_sub_u32 s66, s66, L_pcref-parallel_sum__spectral_fnet__swiglu_ffn__prompt_kernel
    s_subb_u32 s67, s67, 0
    s_mul_i32 s68, s41, 9
    v_add_u32 v4, s68, v0
    v_lshlrev_b32 v4, 7, v4
    v_min_u32 v4, L_done-parallel_sum__spectral_fnet__swiglu_ffn__prompt_kernel, v4
    s_mov_b64 exec, 0x1ff
    global_load_dword v255, v4, s[66:67]
    s_mov_b64 exec, -1
    v_lshrrev_b32 v14, 4, v0
    s_mul_i32 s66, s30, 3
    v_add_u32 v14, s66, v14
    v_lshlrev_b32 v14, 8, v14
    v_bfe_u32 v15, v0, 1, 3
    s_lshl_b32 s66, s32, 3
    v_add_u32 v15, s66, v15
    v_mul_u32_u24 v15, 3072, v15
    v_add_u32 v14, v14, v15
    v_and_b32 v15, 1, v0
    v_lshl_add_u32 v14, v15, 7, v14
    s_mov_b32 s8, s48
    s_mov_b32 s9, s49
    s_mov_b32 s10, 1966080
    s_mov_b32 s11, 0x00020000
    s_mov_b32 s52, s50
    s_mov_b32 s53, s51
    s_mov_b32 s54, 1966080
    s_mov_b32 s55, 0x00020000
    s_add_u32 s64, s34, 2
    s_mov_b32 s61, 2
    s_mov_b32 s60, 17895697
    s_cmp_eq_u32 s35, 0
    s_cbranch_scc1 L_pf_1
    s_cmp_ge_u32 s61, 10
    s_cbranch_scc1 L_pf_1
    s_cmp_ge_u32 s64, 10
    s_cselect_b32 s66, 10, 0
    s_sub_u32 s64, s64, s66
    s_mul_i32 s66, s64, 196608
    s_mov_b32 exec_hi, 0xffff
    buffer_load_dword v15, v14, s[8:11], s66 offen
    buffer_load_dword v15, v14, s[52:55], s66 offen
    s_mov_b64 exec, -1
    s_add_u32 s64, s64, 1
    s_add_u32 s61, s61, 1
L_pf_1:
    v_mov_b32 v48, 0
    v_mov_b32 v49, 0
    v_mov_b32 v50, 0
    v_mov_b32 v51, 0
    v_mov_b32 v52, 0
    v_mov_b32 v53, 0
    v_mov_b32 v54, 0
    v_mov_b32 v55, 0
    v_lshrrev_b32 v4, 2, v0
    v_and_b32 v5, 3, v4
    v_bfe_u32 v6, v4, 3, 1
    v_lshl_or_b32 v5, v6, 2, v5
    v_lshlrev_b32 v5, 1, v5
    s_and_b32 s66, s32, 3
    s_lshl_b32 s66, s66, 2
    v_and_b32 v6, 3, v0
    v_add_u32 v6, s66, v6
    v_xor_b32 v5, v5, v6
    v_lshlrev_b32 v4, 8, v4
    v_lshl_add_u32 v249, v5, 4, v4
    s_lshr_b32 s66, s32, 2
    s_lshl_b32 s66, s66, 14
    v_add_u32 v249, s66, v249
    s_cmp_eq_u32 s35, 0
    s_cbranch_scc1 L_aux_w
    s_and_b32 s67, s32, 3
    s_mul_i32 s67, s67, 2560
    s_add_u32 s66, s66, s67
    v_lshlrev_b32 v249, 4, v0
    v_add_u32 v249, s66, v249
L_aux_w:
    s_mov_b32 s46, 0
    s_lshl_b32 s77, s29, 1
    s_add_u32 s77, s77, s31
    s_lshl_b32 s77, s77, 11
    s_lshr_b32 s67, s32, 2
    s_lshl_b32 s67, s67, 10
    s_add_u32 s77, s77, s67
    s_add_u32 s77, s77, 11665408
    s_and_b32 s67, s32, 3
    s_cmp_eq_u32 s35, 1
    s_cselect_b32 s68, 20, 32
    s_mul_i32 s67, s67, s68
    s_lshl_b32 s67, s67, 3
    s_add_u32 s77, s77, s67
    v_min_u32 v254, 47, v0
    v_lshlrev_b32 v254, 2, v254
    s_mul_i32 s74, s38, 80
    s_add_u32 s75, s74, 79
    s_lshr_b32 s74, s74, 7
    s_lshr_b32 s75, s75, 7
    s_lshl_b32 s74, s74, 8
    s_lshl_b32 s75, s75, 8
    s_add_u32 s74, s74, 11730944
    s_add_u32 s75, s75, 11730944
    v_mov_b32 v8, -1
    v_mov_b32 v9, -1
    v_mov_b32 v10, -1
    v_mov_b32 v11, -1
    v_lshlrev_b32 v12, 4, v0
    s_mul_i32 s76, s28, 393216
    s_mul_i32 s67, s30, 12288
    s_add_u32 s76, s76, s67
    s_mov_b32 s47, 0
    s_mov_b32 s42, 0
    s_waitcnt lgkmcnt(0)
L_aux_l:
    s_barrier
    s_and_b32 s62, s60, 15
    s_lshr_b32 s60, s60, 4
L_pf_2_n:
    s_cmp_eq_u32 s62, 0
    s_cbranch_scc1 L_pf_2
    s_cmp_eq_u32 s35, 0
    s_cbranch_scc1 L_pf_2
    s_cmp_ge_u32 s61, 10
    s_cbranch_scc1 L_pf_2
    s_cmp_ge_u32 s64, 10
    s_cselect_b32 s66, 10, 0
    s_sub_u32 s64, s64, s66
    s_mul_i32 s66, s64, 196608
    s_mov_b32 exec_hi, 0xffff
    buffer_load_dword v15, v14, s[8:11], s66 offen
    buffer_load_dword v15, v14, s[52:55], s66 offen
    s_mov_b64 exec, -1
    s_add_u32 s64, s64, 1
    s_add_u32 s61, s61, 1
    s_sub_u32 s62, s62, 1
    s_branch L_pf_2_n
L_pf_2:
    v_add_u32 v251, s46, v249
    s_add_u32 s66, s47, 1
    s_cmp_lg_u32 s47, 0
    s_cbranch_scc1 L_aux_nb
    s_mov_b64 exec, 1
    buffer_load_dword v2, v1, s[24:27], 0 offen sc1
    s_mov_b64 exec, -1
L_aux_nb:
    s_cmp_lg_u32 s66, 2
    s_cbranch_scc1 L_aux_na
    s_mov_b32 s79, 0
L_non:
    s_waitcnt vmcnt(0)
    v_readfirstlane_b32 s43, v2
    s_cmp_lg_u32 s43, 0
    s_cbranch_scc1 L_non_ok
    s_add_u32 s79, s79, 1
    s_cmp_ge_u32 s79, 1048576
    s_cbranch_scc1 L_non_ok
    s_sleep 4
    s_mov_b64 exec, 1
    buffer_load_dword v2, v1, s[24:27], 0 offen sc1
    s_mov_b64 exec, -1
    s_branch L_non
L_non_ok:
    v_mov_b32 v2, s43
    v_mov_b32 v3, 149536
    ds_write_b32 v3, v2
    s_cmp_ge_u32 s2, 240
    s_cbranch_scc1 L_aux_na
    s_mul_hi_u32 s66, s2, 858993460
    s_mul_i32 s67, s66, 5
    s_sub_u32 s67, s2, s67
    s_lshl_b32 s67, s67, 8
    s_lshl_b32 s66, s66, 2
    s_add_u32 s66, s66, s67
    s_add_u32 s66, s66, 11730944
    s_mov_b64 exec, 1
    buffer_store_dword v2, v1, s[12:15], s66 offen sc1
    s_mov_b64 exec, -1
L_aux_na:
    s_lshr_b32 s63, 139808, s42
    s_and_b32 s63, s63, 15
    s_add_u32 s42, s42, 4
L_aux_rr:
    s_cmp_eq_u32 s63, 0
    s_cbranch_scc1 L_aux_nr
    s_cmp_eq_u32 s35, 0
    s_cbranch_scc1 L_rs_3
    buffer_store_dwordx4 v[8:11], v12, s[12:15], s76 offen offset:1024 sc1
    buffer_store_dwordx4 v[8:11], v12, s[12:15], s76 offen offset:3072 sc1
    s_add_u32 s76, s76, 4096
    buffer_store_dwordx4 v[8:11], v12, s[12:15], s76 offen offset:1024 sc1
    buffer_store_dwordx4 v[8:11], v12, s[12:15], s76 offen offset:3072 sc1
    s_add_u32 s76, s76, 4096
    buffer_store_dwordx4 v[8:11], v12, s[12:15], s76 offen offset:1024 sc1
    buffer_store_dwordx4 v[8:11], v12, s[12:15], s76 offen offset:3072 sc1
    s_add_u32 s76, s76, 40960
L_rs_3:
    s_sub_u32 s63, s63, 1
    s_branch L_aux_rr
L_aux_nr:
    s_cmp_eq_u32 s35, 1
    s_cbranch_scc1 L_aux_c
    ds_read_b128 v[24:27], v251 offset:0
    ds_read_b128 v[28:31], v251 offset:4096
    ds_read_b128 v[32:35], v251 offset:8192
    ds_read_b128 v[36:39], v251 offset:12288
    s_waitcnt lgkmcnt(0)
    v_lshlrev_b32 v252, 16, v24
    v_and_b32 v253, 0xffff0000, v24
    v_add_f32 v48, v48, v252
    v_add_f32 v49, v49, v253
    v_lshlrev_b32 v252, 16, v25
    v_and_b32 v253, 0xffff0000, v25
    v_add_f32 v50, v50, v252
    v_add_f32 v51, v51, v253
    v_lshlrev_b32 v252, 16, v26
    v_and_b32 v253, 0xffff0000, v26
    v_add_f32 v52, v52, v252
    v_add_f32 v53, v53, v253
    v_lshlrev_b32 v252, 16, v27
    v_and_b32 v253, 0xffff0000, v27
    v_add_f32 v54, v54, v252
    v_add_f32 v55, v55, v253
    v_lshlrev_b32 v252, 16, v28
    v_and_b32 v253, 0xffff0000, v28
    v_add_f32 v48, v48, v252
    v_add_f32 v49, v49, v253
    v_lshlrev_b32 v252, 16, v29
    v_and_b32 v253, 0xffff0000, v29
    v_add_f32 v50, v50, v252
    v_add_f32 v51, v51, v253
    v_lshlrev_b32 v252, 16, v30
    v_and_b32 v253, 0xffff0000, v30
    v_add_f32 v52, v52, v252
    v_add_f32 v53, v53, v253
    v_lshlrev_b32 v252, 16, v31
    v_and_b32 v253, 0xffff0000, v31
    v_add_f32 v54, v54, v252
    v_add_f32 v55, v55, v253
    v_lshlrev_b32 v252, 16, v32
    v_and_b32 v253, 0xffff0000, v32
    v_add_f32 v48, v48, v252
    v_add_f32 v49, v49, v253
    v_lshlrev_b32 v252, 16, v33
    v_and_b32 v253, 0xffff0000, v33
    v_add_f32 v50, v50, v252
    v_add_f32 v51, v51, v253
    v_lshlrev_b32 v252, 16, v34
    v_and_b32 v253, 0xffff0000, v34
    v_add_f32 v52, v52, v252
    v_add_f32 v53, v53, v253
    v_lshlrev_b32 v252, 16, v35
    v_and_b32 v253, 0xffff0000, v35
    v_add_f32 v54, v54, v252
    v_add_f32 v55, v55, v253
    v_lshlrev_b32 v252, 16, v36
    v_and_b32 v253, 0xffff0000, v36
    v_add_f32 v48, v48, v252
    v_add_f32 v49, v49, v253
    v_lshlrev_b32 v252, 16, v37
    v_and_b32 v253, 0xffff0000, v37
    v_add_f32 v50, v50, v252
    v_add_f32 v51, v51, v253
    v_lshlrev_b32 v252, 16, v38
    v_and_b32 v253, 0xffff0000, v38
    v_add_f32 v52, v52, v252
    v_add_f32 v53, v53, v253
    v_lshlrev_b32 v252, 16, v39
    v_and_b32 v253, 0xffff0000, v39
    v_add_f32 v54, v54, v252
    v_add_f32 v55, v55, v253
    s_branch L_aux_x
L_aux_c:
    s_branch L_aux_x
    s_bitcmp1_b32 s47, 0
    s_cbranch_scc0 L_aux_x
L_aux_x:
    s_add_u32 s46, s46, 49152
    s_cmp_eq_u32 s46, 147456
    s_cselect_b32 s46, 0, s46
    s_add_u32 s47, s47, 1
    s_cmp_lt_u32 s47, 5
    s_cbranch_scc1 L_aux_l
    s_barrier
    s_and_b32 s62, s60, 15
    s_lshr_b32 s60, s60, 4
L_pf_4_n:
    s_cmp_eq_u32 s62, 0
    s_cbranch_scc1 L_pf_4
    s_cmp_eq_u32 s35, 0
    s_cbranch_scc1 L_pf_4
    s_cmp_ge_u32 s61, 10
    s_cbranch_scc1 L_pf_4
    s_cmp_ge_u32 s64, 10
    s_cselect_b32 s66, 10, 0
    s_sub_u32 s64, s64, s66
    s_mul_i32 s66, s64, 196608
    s_mov_b32 exec_hi, 0xffff
    buffer_load_dword v15, v14, s[8:11], s66 offen
    buffer_load_dword v15, v14, s[52:55], s66 offen
    s_mov_b64 exec, -1
    s_add_u32 s64, s64, 1
    s_add_u32 s61, s61, 1
    s_sub_u32 s62, s62, 1
    s_branch L_pf_4_n
L_pf_4:
    s_cmp_eq_u32 s35, 0
    s_cbranch_scc1 L_rs_5
L_rs_5:
    v_lshlrev_b32 v1, 4, v0
    s_mov_b32 s12, s58
    s_mov_b32 s13, s59
    s_mov_b32 s14, 16777216
    s_mov_b32 s15, 0x00020000
    s_mul_i32 s70, s38, 48
    s_mul_i32 s71, s44, 12
    s_add_u32 s70, s70, s71
    s_mul_i32 s70, s70, 5120
    s_add_u32 s70, s70, 6291456
    s_mul_i32 s73, s44, 10240
    s_cmp_eq_u32 s35, 1
    s_cbranch_scc1 L_aux_pc
    s_nop 1
    v_add_f32_dpp v48, v48, v48 row_ror:4 row_mask:0xf bank_mask:0xf
    v_add_f32_dpp v49, v49, v49 row_ror:4 row_mask:0xf bank_mask:0xf
    v_add_f32_dpp v50, v50, v50 row_ror:4 row_mask:0xf bank_mask:0xf
    v_add_f32_dpp v51, v51, v51 row_ror:4 row_mask:0xf bank_mask:0xf
    v_add_f32_dpp v52, v52, v52 row_ror:4 row_mask:0xf bank_mask:0xf
    v_add_f32_dpp v53, v53, v53 row_ror:4 row_mask:0xf bank_mask:0xf
    v_add_f32_dpp v54, v54, v54 row_ror:4 row_mask:0xf bank_mask:0xf
    v_add_f32_dpp v55, v55, v55 row_ror:4 row_mask:0xf bank_mask:0xf
    s_nop 1
    v_add_f32_dpp v48, v48, v48 row_ror:8 row_mask:0xf bank_mask:0xf
    v_add_f32_dpp v49, v49, v49 row_ror:8 row_mask:0xf bank_mask:0xf
    v_add_f32_dpp v50, v50, v50 row_ror:8 row_mask:0xf bank_mask:0xf
    v_add_f32_dpp v51, v51, v51 row_ror:8 row_mask:0xf bank_mask:0xf
    v_add_f32_dpp v52, v52, v52 row_ror:8 row_mask:0xf bank_mask:0xf
    v_add_f32_dpp v53, v53, v53 row_ror:8 row_mask:0xf bank_mask:0xf
    v_add_f32_dpp v54, v54, v54 row_ror:8 row_mask:0xf bank_mask:0xf
    v_add_f32_dpp v55, v55, v55 row_ror:8 row_mask:0xf bank_mask:0xf
    v_mov_b32 v24, v48
    v_mov_b32 v25, v49
    v_mov_b32 v26, v50
    v_mov_b32 v27, v51
    v_mov_b32 v28, v52
    v_mov_b32 v29, v53
    v_mov_b32 v30, v54
    v_mov_b32 v31, v55
    s_nop 1
    v_permlane16_swap_b32 v48, v24
    v_permlane16_swap_b32 v49, v25
    v_permlane16_swap_b32 v50, v26
    v_permlane16_swap_b32 v51, v27
    v_permlane16_swap_b32 v52, v28
    v_permlane16_swap_b32 v53, v29
    v_permlane16_swap_b32 v54, v30
    v_permlane16_swap_b32 v55, v31
    s_nop 1
    v_add_f32 v48, v48, v24
    v_add_f32 v49, v49, v25
    v_add_f32 v50, v50, v26
    v_add_f32 v51, v51, v27
    v_add_f32 v52, v52, v28
    v_add_f32 v53, v53, v29
    v_add_f32 v54, v54, v30
    v_add_f32 v55, v55, v31
    v_mov_b32 v24, v48
    v_mov_b32 v25, v49
    v_mov_b32 v26, v50
    v_mov_b32 v27, v51
    v_mov_b32 v28, v52
    v_mov_b32 v29, v53
    v_mov_b32 v30, v54
    v_mov_b32 v31, v55
    s_nop 1
    v_permlane32_swap_b32 v48, v24
    v_permlane32_swap_b32 v49, v25
    v_permlane32_swap_b32 v50, v26
    v_permlane32_swap_b32 v51, v27
    v_permlane32_swap_b32 v52, v28
    v_permlane32_swap_b32 v53, v29
    v_permlane32_swap_b32 v54, v30
    v_permlane32_swap_b32 v55, v31
    s_nop 1
    v_add_f32 v48, v48, v24
    v_add_f32 v49, v49, v25
    v_add_f32 v50, v50, v26
    v_add_f32 v51, v51, v27
    v_add_f32 v52, v52, v28
    v_add_f32 v53, v53, v29
    v_add_f32 v54, v54, v30
    v_add_f32 v55, v55, v31
    v_lshrrev_b32 v6, 2, v0
    v_mov_b32 v24, v48
    v_mov_b32 v26, v49
    v_cmp_eq_u32 vcc, 1, v6
    s_nop 1
    v_cndmask_b32 v24, v24, v50, vcc
    v_cndmask_b32 v26, v26, v51, vcc
    v_cmp_eq_u32 vcc, 2, v6
    s_nop 1
    v_cndmask_b32 v24, v24, v52, vcc
    v_cndmask_b32 v26, v26, v53, vcc
    v_cmp_eq_u32 vcc, 3, v6
    s_nop 1
    v_cndmask_b32 v24, v24, v54, vcc
    v_cndmask_b32 v26, v26, v55, vcc
    v_mov_b32 v25, s43
    v_mov_b32 v27, s43
    v_and_b32 v4, 3, v0
    v_lshlrev_b32 v4, 6, v4
    v_lshl_add_u32 v4, v6, 4, v4
    s_mov_b64 exec, 0xffff
    buffer_store_dwordx4 v[24:27], v4, s[12:15], s77 offen sc1
    s_branch L_aux_pub
L_aux_pc:
    s_branch L_aux_pub
L_aux_pub:
    s_mov_b64 exec, -1
    s_lshl_b32 s48, s28, 13
    s_add_u32 s48, s48, 11534336
    s_add_u32 s50, s48, 4096
    s_lshl_b32 s49, s29, 12
    s_add_u32 s49, s49, 11665408
    s_mov_b32 s65, 11735040
    v_and_b32 v248, 3, v0
    v_lshlrev_b32 v248, 2, v248
    s_lshl_b32 s69, s36, 8
    s_add_u32 s69, s69, 48
    v_add_u32 v248, s69, v248
    s_lshl_b32 s69, s28, 8
    s_lshl_b32 s63, s30, 2
    s_add_u32 s69, s69, s63
    s_add_u32 s69, s69, 48
    v_mov_b32 v4, s69
    v_cmp_gt_u32 vcc, 16, v0
    s_nop 1
    v_cndmask_b32 v248, v4, v248, vcc
    s_barrier
    s_lshl_b32 s66, s28, 8
    s_lshl_b32 s67, s29, 2
    s_add_u32 s66, s66, s67
    s_add_u32 s66, s66, 11735040
    v_mov_b32 v4, s43
    v_mov_b32 v5, 0
    s_waitcnt vmcnt(0)
    s_mov_b64 exec, 1
    buffer_store_dword v4, v5, s[12:15], s66 offen sc1
    s_mov_b64 exec, -1
    s_and_b32 s62, s60, 15
    s_lshr_b32 s60, s60, 4
L_pf_6_n:
    s_cmp_eq_u32 s62, 0
    s_cbranch_scc1 L_pf_6
    s_cmp_eq_u32 s35, 0
    s_cbranch_scc1 L_pf_6
    s_cmp_ge_u32 s61, 10
    s_cbranch_scc1 L_pf_6
    s_cmp_ge_u32 s64, 10
    s_cselect_b32 s66, 10, 0
    s_sub_u32 s64, s64, s66
    s_mul_i32 s66, s64, 196608
    s_mov_b32 exec_hi, 0xffff
    buffer_load_dword v15, v14, s[8:11], s66 offen
    buffer_load_dword v15, v14, s[52:55], s66 offen
    s_mov_b64 exec, -1
    s_add_u32 s64, s64, 1
    s_add_u32 s61, s61, 1
    s_sub_u32 s62, s62, 1
    s_branch L_pf_6_n
L_pf_6:
    s_cmp_eq_u32 s35, 0
    s_cbranch_scc1 L_rs_7
L_rs_7:
    buffer_load_dword v62, v254, s[12:15], s74 offen sc1
    buffer_load_dword v63, v254, s[12:15], s75 offen sc1
    s_barrier
    s_mov_b32 s79, 0
L_pollwf:
    s_waitcnt vmcnt(0)
    v_cmp_ne_u32 vcc, s43, v62
    v_cmp_ne_u32 s[66:67], s43, v63
    s_or_b64 vcc, vcc, s[66:67]
    s_cbranch_scc0 L_pollwf_ok
    s_add_u32 s79, s79, 1
    s_cmp_ge_u32 s79, 1048576
    s_cbranch_scc1 L_pollwf_ok
    s_sleep 4
    buffer_load_dword v62, v254, s[12:15], s74 offen sc1
    buffer_load_dword v63, v254, s[12:15], s75 offen sc1
    s_branch L_pollwf
L_pollwf_ok:
    s_cmp_eq_u32 s35, 1
    s_cselect_b32 s69, 0, 64
    v_cmp_gt_u32 s[76:77], s69, v0
    s_barrier
    buffer_load_dwordx4 v[8:11], v1, s[12:15], s48 offen offset:0 sc1
    buffer_load_dwordx4 v[12:15], v1, s[12:15], s48 offen offset:1024 sc1
    buffer_load_dwordx4 v[16:19], v1, s[12:15], s48 offen offset:2048 sc1
    buffer_load_dwordx4 v[20:23], v1, s[12:15], s48 offen offset:3072 sc1
    buffer_load_dwordx4 v[24:27], v1, s[12:15], s50 offen offset:0 sc1
    buffer_load_dwordx4 v[28:31], v1, s[12:15], s50 offen offset:1024 sc1
    buffer_load_dwordx4 v[32:35], v1, s[12:15], s50 offen offset:2048 sc1
    buffer_load_dwordx4 v[36:39], v1, s[12:15], s50 offen offset:3072 sc1
    s_cmp_eq_u32 s35, 1
    s_cbranch_scc1 L_gw_8
    buffer_load_dwordx4 v[40:43], v1, s[12:15], s49 offen offset:0 sc1
    buffer_load_dwordx4 v[44:47], v1, s[12:15], s49 offen offset:1024 sc1
    buffer_load_dwordx4 v[48:51], v1, s[12:15], s49 offen offset:2048 sc1
    buffer_load_dwordx4 v[52:55], v1, s[12:15], s49 offen offset:3072 sc1
L_gw_8:
    buffer_load_dword v249, v248, s[12:15], s65 offen sc1
L_g8x:
    s_mov_b32 s79, 0
    s_waitcnt vmcnt(0)
L_gchk:
    v_xor_b32 v2, s43, v249
    s_mov_b32 s64, 0
    v_and_b32 v2, s64, v2
    v_xor_b32 v3, s43, v10
    v_or_b32 v2, v2, v3
    v_xor_b32 v3, s43, v14
    v_or_b32 v2, v2, v3
    v_xor_b32 v3, s43, v18
    v_or_b32 v2, v2, v3
    v_xor_b32 v3, s43, v22
    v_or_b32 v2, v2, v3
    v_xor_b32 v3, s43, v26
    v_or_b32 v2, v2, v3
    v_xor_b32 v3, s43, v30
    v_or_b32 v2, v2, v3
    v_xor_b32 v3, s43, v34
    v_or_b32 v2, v2, v3
    v_xor_b32 v3, s43, v38
    v_or_b32 v2, v2, v3
    v_xor_b32 v4, s43, v41
    v_xor_b32 v3, s43, v43
    v_or_b32 v4, v4, v3
    v_xor_b32 v3, s43, v45
    v_or_b32 v4, v4, v3
    v_xor_b32 v3, s43, v47
    v_or_b32 v4, v4, v3
    v_xor_b32 v3, s43, v49
    v_or_b32 v4, v4, v3
    v_xor_b32 v3, s43, v51
    v_or_b32 v4, v4, v3
    v_xor_b32 v3, s43, v53
    v_or_b32 v4, v4, v3
    v_xor_b32 v3, s43, v55
    v_or_b32 v4, v4, v3
    v_cmp_ne_u32 vcc, 0, v4
    s_and_b64 s[62:63], vcc, s[76:77]
    v_cmp_ne_u32 vcc, 0, v2
    s_or_b64 s[62:63], s[62:63], vcc
    s_cbranch_scc0 L_gok
    s_add_u32 s79, s79, 1
    s_cmp_ge_u32 s79, 1048576
    s_cbranch_scc1 L_gok
    s_sleep 4
    buffer_load_dwordx4 v[8:11], v1, s[12:15], s48 offen offset:0 sc1
    buffer_load_dwordx4 v[12:15], v1, s[12:15], s48 offen offset:1024 sc1
    buffer_load_dwordx4 v[16:19], v1, s[12:15], s48 offen offset:2048 sc1
    buffer_load_dwordx4 v[20:23], v1, s[12:15], s48 offen offset:3072 sc1
    buffer_load_dwordx4 v[24:27], v1, s[12:15], s50 offen offset:0 sc1
    buffer_load_dwordx4 v[28:31], v1, s[12:15], s50 offen offset:1024 sc1
    buffer_load_dwordx4 v[32:35], v1, s[12:15], s50 offen offset:2048 sc1
    buffer_load_dwordx4 v[36:39], v1, s[12:15], s50 offen offset:3072 sc1
    s_cmp_eq_u32 s35, 1
    s_cbranch_scc1 L_gw_9
    buffer_load_dwordx4 v[40:43], v1, s[12:15], s49 offen offset:0 sc1
    buffer_load_dwordx4 v[44:47], v1, s[12:15], s49 offen offset:1024 sc1
    buffer_load_dwordx4 v[48:51], v1, s[12:15], s49 offen offset:2048 sc1
    buffer_load_dwordx4 v[52:55], v1, s[12:15], s49 offen offset:3072 sc1
L_gw_9:
    buffer_load_dword v249, v248, s[12:15], s65 offen sc1
    s_waitcnt vmcnt(0)
    s_branch L_gchk
L_gok:
    v_add_f32 v8, v8, v16
    v_add_f32 v24, v24, v32
    v_add_f32 v8, v8, v24
    v_add_f32 v9, v9, v17
    v_add_f32 v25, v25, v33
    v_add_f32 v9, v9, v25
    v_add_f32 v40, v40, v48
    v_add_f32 v41, v42, v50
    v_add_f32 v12, v12, v20
    v_add_f32 v28, v28, v36
    v_add_f32 v12, v12, v28
    v_add_f32 v13, v13, v21
    v_add_f32 v29, v29, v37
    v_add_f32 v13, v13, v29
    v_add_f32 v44, v44, v52
    v_add_f32 v45, v46, v54
    v_lshlrev_b32 v2, 3, v0
    v_add_u32 v2, 148480, v2
    ds_write_b64 v2, v[40:41]
    ds_write_b64 v2, v[44:45] offset:512
    v_mul_f32 v18, 0.0015625, v8
    v_mul_f32 v9, 0.0015625, v9
    v_fma_f32 v9, -v18, v18, v9
    v_max_f32 v9, 0, v9
    v_cvt_pk_bf16_f32 v18, v18, v18
    v_lshlrev_b32 v18, 16, v18
    v_cvt_pk_bf16_f32 v9, v9, v9
    v_lshlrev_b32 v9, 16, v9
    v_add_f32 v9, 0x3727c5ac, v9
    v_cvt_pk_bf16_f32 v9, v9, v9
    v_lshlrev_b32 v9, 16, v9
    v_sqrt_f32 v9, v9
    s_nop 0
    v_cvt_pk_bf16_f32 v9, v9, v9
    v_lshlrev_b32 v9, 16, v9
    v_rcp_f32 v16, v9
    v_fmac_f32 v8, -640.0, v18
    v_mul_f32 v8, v8, v16
    v_mul_f32 v19, 0.0015625, v12
    v_mul_f32 v13, 0.0015625, v13
    v_fma_f32 v13, -v19, v19, v13
    v_max_f32 v13, 0, v13
    v_cvt_pk_bf16_f32 v19, v19, v19
    v_lshlrev_b32 v19, 16, v19
    v_cvt_pk_bf16_f32 v13, v13, v13
    v_lshlrev_b32 v13, 16, v13
    v_add_f32 v13, 0x3727c5ac, v13
    v_cvt_pk_bf16_f32 v13, v13, v13
    v_lshlrev_b32 v13, 16, v13
    v_sqrt_f32 v13, v13
    s_nop 0
    v_cvt_pk_bf16_f32 v13, v13, v13
    v_lshlrev_b32 v13, 16, v13
    v_rcp_f32 v17, v13
    v_fmac_f32 v12, -640.0, v19
    v_mul_f32 v12, v12, v17
    v_lshlrev_b32 v2, 2, v0
    v_add_u32 v2, 147456, v2
    ds_write_b32 v2, v8 offset:2560
    ds_write_b32 v2, v12 offset:2816
    ds_write_b32 v2, v16
    ds_write_b32 v2, v17 offset:256
    ds_write_b32 v2, v18 offset:512
    ds_write_b32 v2, v19 offset:768
    v_mov_b32 v2, 149504
    v_mov_b32 v3, 1
    s_waitcnt lgkmcnt(0)
    s_mov_b64 exec, 1
    ds_add_u32 v2, v3 offset:24
    s_mov_b64 exec, -1
    v_cmp_ne_u32 vcc, s43, v249
    s_cmp_eq_u64 vcc, 0
    s_cbranch_scc1 L_pollr_ok
    s_mov_b32 s79, 0
L_pollr:
    buffer_load_dword v249, v248, s[12:15], s65 offen sc1
    s_waitcnt vmcnt(0)
    v_cmp_ne_u32 vcc, s43, v249
    s_cmp_eq_u64 vcc, 0
    s_cbranch_scc1 L_pollr_ok
    s_add_u32 s79, s79, 1
    s_cmp_ge_u32 s79, 1048576
    s_cbranch_scc1 L_pollr_ok
    s_sleep 4
    s_branch L_pollr
L_pollr_ok:
    v_mov_b32 v2, 149504
    v_mov_b32 v3, 1
    s_waitcnt lgkmcnt(0)
    s_mov_b64 exec, 1
    ds_add_u32 v2, v3 offset:48
    s_mov_b64 exec, -1
    s_branch L_p2join
L_compute:
    s_waitcnt lgkmcnt(0)
    s_mov_b32 s12, s58
    s_mov_b32 s13, s59
    s_mov_b32 s14, 16777216
    s_mov_b32 s15, 0x00020000
    s_mov_b32 s4, s64
    s_mov_b32 s5, s65
    s_mov_b32 s6, 2621440
    s_mov_b32 s7, 0x00020000
    s_mov_b32 s16, s54
    s_mov_b32 s17, s55
    s_mov_b32 s18, 2621440
    s_mov_b32 s19, 0x00020000
    s_mov_b32 s20, s52
    s_mov_b32 s21, s53
    s_mov_b32 s22, 1966080
    s_mov_b32 s23, 0x00020000
    s_mov_b32 s24, s56
    s_mov_b32 s25, s57
    s_mov_b32 s26, 256
    s_mov_b32 s27, 0x00020000
    s_mov_b32 s50, 4294868992
    s_mov_b32 s51, 49152
    s_mov_b32 s46, 0
    s_mov_b32 s47, 0
    s_cmp_ge_u32 s38, 4
    s_cselect_b32 s55, 1, 0
    s_sub_u32 s67, 16, s36
    s_xor_b32 s68, s37, 1
    s_cmp_eq_u32 s55, 1
    s_cselect_b32 s67, s67, s36
    s_cselect_b32 s68, s68, s37
    s_and_b32 s60, s67, 3
    s_lshl_b32 s60, s60, 7
    s_add_u32 s60, s60, 11747328
    s_lshl_b32 s67, s67, 1
    s_add_u32 s67, s67, s68
    s_mul_i32 s67, s67, 5248
    s_add_u32 s56, s67, 8388608
    s_lshl_b32 s57, s55, 9
    s_sub_u32 s57, 256, s57
    v_lshrrev_b32 v2, 4, v0
    v_and_b32 v3, 15, v0
    v_bfe_u32 v6, v0, 1, 3
    v_xor_b32 v6, v6, v2
    s_cmp_ge_u32 s2, 240
    s_cbranch_scc1 L_nowd_10
    s_mul_hi_u32 s76, s2, 858993460
    s_mul_i32 s77, s76, 5
    s_sub_u32 s77, s2, s77
    v_lshrrev_b32 v36, 2, v0
    v_and_b32 v37, 3, v0
    v_mul_u32_u24 v38, 1280, v36
    v_lshl_add_u32 v38, v37, 4, v38
    s_mul_i32 s68, s76, 40960
    s_lshl_b32 s69, s77, 8
    s_add_u32 s68, s68, s69
    s_lshl_b32 s69, s3, 6
    s_add_u32 s68, s68, s69
    s_lshl_b32 s70, s3, 11
    s_add_u32 s70, s70, 151552
    s_mov_b32 m0, s70
    s_nop 0
    buffer_load_dwordx4 v38, s[20:23], s68 offen  lds
    s_add_u32 m0, s70, 1024
    s_add_u32 s68, s68, 20480
    buffer_load_dwordx4 v38, s[20:23], s68 offen  lds
L_nowd_10:
    s_lshl_b32 s66, s3, 6
    s_add_u32 s66, s66, 0
    v_add_u32 v16, s66, v0
    v_mul_u32_u24 v17, 6554, v16
    v_lshrrev_b32 v17, 16, v17
    v_mul_u32_u24 v40, 10, v17
    v_sub_u32 v40, v16, v40
    v_lshrrev_b32 v41, 4, v17
    v_and_b32 v17, 15, v17
    v_lshrrev_b32 v43, 1, v40
    v_mov_b32 v44, 49152
    v_mov_b32 v18, 40960
    v_cmp_eq_u32 vcc, 1, v43
    v_mov_b32 v45, 53568
    v_mov_b32 v46, 90176
    v_cndmask_b32 v44, v44, v45, vcc
    v_cndmask_b32 v18, v18, v46, vcc
    v_cmp_eq_u32 vcc, 2, v43
    v_mov_b32 v45, 98432
    v_mov_b32 v46, 139392
    v_cndmask_b32 v44, v44, v45, vcc
    v_cndmask_b32 v18, v18, v46, vcc
    v_cmp_eq_u32 vcc, 3, v43
    v_mov_b32 v45, 102848
    v_mov_b32 v46, 151744
    v_cndmask_b32 v44, v44, v45, vcc
    v_cndmask_b32 v18, v18, v46, vcc
    v_cmp_eq_u32 vcc, 4, v43
    v_mov_b32 v45, 0
    v_mov_b32 v46, 156160
    v_cndmask_b32 v44, v44, v45, vcc
    v_cndmask_b32 v18, v18, v46, vcc
    v_and_b32 v42, 1, v40
    v_mul_u32_u24 v16, 544, v42
    v_mul_u32_u24 v42, 1088, v41
    v_add_u32 v16, v16, v42
    v_lshl_add_u32 v16, v17, 4, v16
    v_add_u32 v18, v18, v16
    v_add_u32 v16, v44, v16
    v_lshrrev_b32 v42, 2, v17
    v_and_b32 v17, 3, v17
    v_lshl_add_u32 v17, v17, 2, v42
    v_lshlrev_b32 v17, 3, v17
    v_add_u32 v17, v17, v41
    v_lshlrev_b32 v17, 4, v17
    s_lshl_b32 s66, s37, 6
    s_add_u32 s66, s66, s36
    v_add_u32 v17, s66, v17
    v_mul_u32_u24 v17, 1280, v17
    v_lshl_add_u32 v17, v40, 4, v17
    s_mul_i32 s66, s38, 160
    v_add_u32 v17, s66, v17
    s_lshl_b32 s66, s3, 6
    s_add_u32 s66, s66, 256
    v_add_u32 v19, s66, v0
    v_mul_u32_u24 v20, 6554, v19
    v_lshrrev_b32 v20, 16, v20
    v_mul_u32_u24 v40, 10, v20
    v_sub_u32 v40, v19, v40
    v_lshrrev_b32 v41, 4, v20
    v_and_b32 v20, 15, v20
    v_lshrrev_b32 v43, 1, v40
    v_mov_b32 v44, 49152
    v_mov_b32 v21, 40960
    v_cmp_eq_u32 vcc, 1, v43
    v_mov_b32 v45, 53568
    v_mov_b32 v46, 90176
    v_cndmask_b32 v44, v44, v45, vcc
    v_cndmask_b32 v21, v21, v46, vcc
    v_cmp_eq_u32 vcc, 2, v43
    v_mov_b32 v45, 98432
    v_mov_b32 v46, 139392
    v_cndmask_b32 v44, v44, v45, vcc
    v_cndmask_b32 v21, v21, v46, vcc
    v_cmp_eq_u32 vcc, 3, v43
    v_mov_b32 v45, 102848
    v_mov_b32 v46, 151744
    v_cndmask_b32 v44, v44, v45, vcc
    v_cndmask_b32 v21, v21, v46, vcc
    v_cmp_eq_u32 vcc, 4, v43
    v_mov_b32 v45, 0
    v_mov_b32 v46, 156160
    v_cndmask_b32 v44, v44, v45, vcc
    v_cndmask_b32 v21, v21, v46, vcc
    v_and_b32 v42, 1, v40
    v_mul_u32_u24 v19, 544, v42
    v_mul_u32_u24 v42, 1088, v41
    v_add_u32 v19, v19, v42
    v_lshl_add_u32 v19, v20, 4, v19
    v_add_u32 v21, v21, v19
    v_add_u32 v19, v44, v19
    v_lshrrev_b32 v42, 2, v20
    v_and_b32 v20, 3, v20
    v_lshl_add_u32 v20, v20, 2, v42
    v_lshlrev_b32 v20, 3, v20
    v_add_u32 v20, v20, v41
    v_lshlrev_b32 v20, 4, v20
    s_lshl_b32 s66, s37, 6
    s_add_u32 s66, s66, s36
    v_add_u32 v20, s66, v20
    v_mul_u32_u24 v20, 1280, v20
    v_lshl_add_u32 v20, v40, 4, v20
    s_mul_i32 s66, s38, 160
    v_add_u32 v20, s66, v20
    s_lshl_b32 s66, s3, 6
    s_add_u32 s66, s66, 512
    v_add_u32 v22, s66, v0
    v_mul_u32_u24 v23, 6554, v22
    v_lshrrev_b32 v23, 16, v23
    v_mul_u32_u24 v40, 10, v23
    v_sub_u32 v40, v22, v40
    v_lshrrev_b32 v41, 4, v23
    v_and_b32 v23, 15, v23
    v_lshrrev_b32 v43, 1, v40
    v_mov_b32 v44, 49152
    v_mov_b32 v24, 40960
    v_cmp_eq_u32 vcc, 1, v43
    v_mov_b32 v45, 53568
    v_mov_b32 v46, 90176
    v_cndmask_b32 v44, v44, v45, vcc
    v_cndmask_b32 v24, v24, v46, vcc
    v_cmp_eq_u32 vcc, 2, v43
    v_mov_b32 v45, 98432
    v_mov_b32 v46, 139392
    v_cndmask_b32 v44, v44, v45, vcc
    v_cndmask_b32 v24, v24, v46, vcc
    v_cmp_eq_u32 vcc, 3, v43
    v_mov_b32 v45, 102848
    v_mov_b32 v46, 151744
    v_cndmask_b32 v44, v44, v45, vcc
    v_cndmask_b32 v24, v24, v46, vcc
    v_cmp_eq_u32 vcc, 4, v43
    v_mov_b32 v45, 0
    v_mov_b32 v46, 156160
    v_cndmask_b32 v44, v44, v45, vcc
    v_cndmask_b32 v24, v24, v46, vcc
    v_and_b32 v42, 1, v40
    v_mul_u32_u24 v22, 544, v42
    v_mul_u32_u24 v42, 1088, v41
    v_add_u32 v22, v22, v42
    v_lshl_add_u32 v22, v23, 4, v22
    v_add_u32 v24, v24, v22
    v_add_u32 v22, v44, v22
    v_lshrrev_b32 v42, 2, v23
    v_and_b32 v23, 3, v23
    v_lshl_add_u32 v23, v23, 2, v42
    v_lshlrev_b32 v23, 3, v23
    v_add_u32 v23, v23, v41
    v_lshlrev_b32 v23, 4, v23
    s_lshl_b32 s66, s37, 6
    s_add_u32 s66, s66, s36
    v_add_u32 v23, s66, v23
    v_mul_u32_u24 v23, 1280, v23
    v_lshl_add_u32 v23, v40, 4, v23
    s_mul_i32 s66, s38, 160
    v_add_u32 v23, s66, v23
    s_cmp_ge_u32 s3, 2
    s_cselect_b32 s66, -1, 0
    v_or_b32 v23, s66, v23
    v_lshrrev_b32 v27, 4, v0
    v_lshlrev_b32 v27, 9, v27
    v_and_b32 v40, 15, v0
    v_lshl_add_u32 v27, v40, 2, v27
    s_mul_i32 s66, s38, 80
    s_lshl_b32 s67, s3, 4
    s_add_u32 s66, s66, s67
    v_add_u32 v40, s66, v3
    v_sub_u32 v41, 640, v40
    s_cmp_eq_u32 s55, 1
    s_cselect_b64 vcc, -1, 0
    s_nop 1
    v_cndmask_b32 v40, v40, v41, vcc
    v_and_b32 v41, 1, v40
    v_mul_u32_u24 v41, 160, v41
    v_add_u32 v42, 335, v40
    v_lshrrev_b32 v42, 1, v42
    v_sub_u32 v42, v42, v41
    v_cmp_eq_u32 vcc, 0, v40
    v_mul_u32_u24 v43, 713728, v2
    s_nop 0
    v_cndmask_b32 v42, v42, 7, vcc
    v_lshl_add_u32 v25, v42, 4, v43
    s_mul_i32 s66, s38, 80
    s_lshl_b32 s67, 4, 4
    s_add_u32 s66, s66, s67
    v_add_u32 v40, s66, v3
    v_sub_u32 v41, 640, v40
    s_cmp_eq_u32 s55, 1
    s_cselect_b64 vcc, -1, 0
    s_nop 1
    v_cndmask_b32 v40, v40, v41, vcc
    v_and_b32 v41, 1, v40
    v_mul_u32_u24 v41, 160, v41
    v_add_u32 v42, 335, v40
    v_lshrrev_b32 v42, 1, v42
    v_sub_u32 v42, v42, v41
    v_cmp_eq_u32 vcc, 0, v40
    v_mul_u32_u24 v43, 713728, v2
    s_nop 0
    v_cndmask_b32 v42, v42, 7, vcc
    v_lshl_add_u32 v26, v42, 4, v43
    s_cmp_eq_u32 s35, 1
    s_cbranch_scc1 L_dft
    s_and_b32 s44, s3, 1
    s_lshr_b32 s45, s3, 1
    v_bfe_u32 v7, v0, 2, 2
    v_lshl_add_u32 v4, v2, 3, v7
    v_lshlrev_b32 v4, 8, v4
    v_bfe_u32 v5, v0, 1, 1
    v_lshl_add_u32 v4, v5, 4, v4
    v_and_b32 v5, 1, v0
    v_lshl_add_u32 v4, v5, 3, v4
    v_and_b32 v5, 1, v2
    v_lshl_or_b32 v5, v5, 2, v7
    s_lshl_b32 s66, s44, 2
    s_add_u32 s66, s66, 0
    v_xor_b32 v7, s66, v5
    v_lshl_add_u32 v8, v7, 5, v4
    s_lshl_b32 s66, s44, 2
    s_add_u32 s66, s66, 1
    v_xor_b32 v7, s66, v5
    v_lshl_add_u32 v9, v7, 5, v4
    s_lshl_b32 s66, s44, 2
    s_add_u32 s66, s66, 2
    v_xor_b32 v7, s66, v5
    v_lshl_add_u32 v10, v7, 5, v4
    s_lshl_b32 s66, s44, 2
    s_add_u32 s66, s66, 3
    v_xor_b32 v7, s66, v5
    v_lshl_add_u32 v11, v7, 5, v4
    s_lshl_b32 s66, s45, 13
    s_add_u32 s66, s66, 32768
    v_lshlrev_b32 v5, 7, v3
    v_add_u32 v5, s66, v5
    v_xor_b32 v7, 0, v6
    v_lshl_add_u32 v12, v7, 4, v5
    v_xor_b32 v7, 4, v6
    v_lshl_add_u32 v13, v7, 4, v5
    v_mov_b32 v128, 0
    v_mov_b32 v129, 0
    v_mov_b32 v130, 0
    v_mov_b32 v131, 0
    v_mov_b32 v132, 0
    v_mov_b32 v133, 0
    v_mov_b32 v134, 0
    v_mov_b32 v135, 0
    v_mov_b32 v136, 0
    v_mov_b32 v137, 0
    v_mov_b32 v138, 0
    v_mov_b32 v139, 0
    v_mov_b32 v140, 0
    v_mov_b32 v141, 0
    v_mov_b32 v142, 0
    v_mov_b32 v143, 0
    v_mov_b32 v144, 0
    v_mov_b32 v145, 0
    v_mov_b32 v146, 0
    v_mov_b32 v147, 0
    v_mov_b32 v148, 0
    v_mov_b32 v149, 0
    v_mov_b32 v150, 0
    v_mov_b32 v151, 0
    v_mov_b32 v152, 0
    v_mov_b32 v153, 0
    v_mov_b32 v154, 0
    v_mov_b32 v155, 0
    v_mov_b32 v156, 0
    v_mov_b32 v157, 0
    v_mov_b32 v158, 0
    v_mov_b32 v159, 0
    v_mov_b32 v160, 0
    v_mov_b32 v161, 0
    v_mov_b32 v162, 0
    v_mov_b32 v163, 0
    v_mov_b32 v164, 0
    v_mov_b32 v165, 0
    v_mov_b32 v166, 0
    v_mov_b32 v167, 0
    v_mov_b32 v168, 0
    v_mov_b32 v169, 0
    v_mov_b32 v170, 0
    v_mov_b32 v171, 0
    v_mov_b32 v172, 0
    v_mov_b32 v173, 0
    v_mov_b32 v174, 0
    v_mov_b32 v175, 0
    v_mov_b32 v176, 0
    v_mov_b32 v177, 0
    v_mov_b32 v178, 0
    v_mov_b32 v179, 0
    v_mov_b32 v180, 0
    v_mov_b32 v181, 0
    v_mov_b32 v182, 0
    v_mov_b32 v183, 0
    v_mov_b32 v184, 0
    v_mov_b32 v185, 0
    v_mov_b32 v186, 0
    v_mov_b32 v187, 0
    v_mov_b32 v188, 0
    v_mov_b32 v189, 0
    v_mov_b32 v190, 0
    v_mov_b32 v191, 0
    v_mov_b32 v192, 0
    v_mov_b32 v193, 0
    v_mov_b32 v194, 0
    v_mov_b32 v195, 0
    v_mov_b32 v196, 0
    v_mov_b32 v197, 0
    v_mov_b32 v198, 0
    v_mov_b32 v199, 0
    v_mov_b32 v200, 0
    v_mov_b32 v201, 0
    v_mov_b32 v202, 0
    v_mov_b32 v203, 0
    v_mov_b32 v204, 0
    v_mov_b32 v205, 0
    v_mov_b32 v206, 0
    v_mov_b32 v207, 0
    v_mov_b32 v208, 0
    v_mov_b32 v209, 0
    v_mov_b32 v210, 0
    v_mov_b32 v211, 0
    v_mov_b32 v212, 0
    v_mov_b32 v213, 0
    v_mov_b32 v214, 0
    v_mov_b32 v215, 0
    v_mov_b32 v216, 0
    v_mov_b32 v217, 0
    v_mov_b32 v218, 0
    v_mov_b32 v219, 0
    v_mov_b32 v220, 0
    v_mov_b32 v221, 0
    v_mov_b32 v222, 0
    v_mov_b32 v223, 0
    v_mov_b32 v224, 0
    v_mov_b32 v225, 0
    v_mov_b32 v226, 0
    v_mov_b32 v227, 0
    v_mov_b32 v228, 0
    v_mov_b32 v229, 0
    v_mov_b32 v230, 0
    v_mov_b32 v231, 0
    v_mov_b32 v232, 0
    v_mov_b32 v233, 0
    v_mov_b32 v234, 0
    v_mov_b32 v235, 0
    v_mov_b32 v236, 0
    v_mov_b32 v237, 0
    v_mov_b32 v238, 0
    v_mov_b32 v239, 0
    v_mov_b32 v240, 0
    v_mov_b32 v241, 0
    v_mov_b32 v242, 0
    v_mov_b32 v243, 0
    v_mov_b32 v244, 0
    v_mov_b32 v245, 0
    v_mov_b32 v246, 0
    v_mov_b32 v247, 0
    v_mov_b32 v248, 0
    v_mov_b32 v249, 0
    v_mov_b32 v250, 0
    v_mov_b32 v251, 0
    v_mov_b32 v252, 0
    v_mov_b32 v253, 0
    v_mov_b32 v254, 0
    v_mov_b32 v255, 0
    s_cmp_ge_u32 s2, 240
    s_cbranch_scc1 L_wdf_11
    v_lshlrev_b32 v36, 6, v36
    v_lshl_add_u32 v36, v37, 3, v36
    v_add_u32 v36, s70, v36
    v_lshlrev_b32 v37, 4, v0
    s_lshl_b32 s77, s77, 3
    s_lshl_b32 s68, s3, 1
    s_add_u32 s77, s77, s68
    s_mul_i32 s76, s76, 5120
    s_add_u32 s76, s76, 6291456
    s_waitcnt vmcnt(0)
    ds_read_b64_tr_b16 v[48:49], v36 offset:0
    ds_read_b64_tr_b16 v[50:51], v36 offset:1024
    ds_read_b64_tr_b16 v[52:53], v36 offset:32
    ds_read_b64_tr_b16 v[54:55], v36 offset:1056
    s_add_u32 s68, s77, 0
    s_mul_hi_u32 s69, s68, 858993460
    s_mul_i32 s70, s69, 5
    s_sub_u32 s70, s68, s70
    s_mul_i32 s69, s69, 245760
    s_lshl_b32 s70, s70, 10
    s_add_u32 s69, s69, s70
    s_add_u32 s69, s69, s76
    s_waitcnt lgkmcnt(0)
    buffer_store_dwordx4 v[48:51], v37, s[12:15], s69 offen sc1
    s_add_u32 s68, s77, 1
    s_mul_hi_u32 s69, s68, 858993460
    s_mul_i32 s70, s69, 5
    s_sub_u32 s70, s68, s70
    s_mul_i32 s69, s69, 245760
    s_lshl_b32 s70, s70, 10
    s_add_u32 s69, s69, s70
    s_add_u32 s69, s69, s76
    s_waitcnt lgkmcnt(0)
    buffer_store_dwordx4 v[52:55], v37, s[12:15], s69 offen sc1
L_wdf_11:
    v_mov_b32 v5, 1
    v_mov_b32 v6, 149504
    s_barrier
    ds_read_b64_tr_b16 v[32:33], v8 offset:0
    ds_read_b64_tr_b16 v[34:35], v8 offset:1024
    ds_read_b128 v[64:67], v12 offset:0
    ds_read_b128 v[68:71], v12 offset:2048
    ds_read_b128 v[72:75], v12 offset:4096
    ds_read_b128 v[76:79], v12 offset:6144
    ds_read_b64_tr_b16 v[36:37], v9 offset:0
    ds_read_b64_tr_b16 v[38:39], v9 offset:1024
    ds_read_b64_tr_b16 v[40:41], v10 offset:0
    ds_read_b64_tr_b16 v[42:43], v10 offset:1024
    ds_read_b64_tr_b16 v[44:45], v11 offset:0
    ds_read_b64_tr_b16 v[46:47], v11 offset:1024
    ds_read_b64_tr_b16 v[48:49], v8 offset:16384
    ds_read_b64_tr_b16 v[50:51], v8 offset:17408
    ds_read_b64_tr_b16 v[52:53], v9 offset:16384
    ds_read_b64_tr_b16 v[54:55], v9 offset:17408
    ds_read_b64_tr_b16 v[56:57], v10 offset:16384
    ds_read_b64_tr_b16 v[58:59], v10 offset:17408
    ds_read_b64_tr_b16 v[60:61], v11 offset:16384
    ds_read_b64_tr_b16 v[62:63], v11 offset:17408
L_floop:
    s_waitcnt lgkmcnt(0)
    v_mfma_f32_16x16x32_bf16 v[128:131], v[32:35], v[64:67], v[128:131]
    ds_read_b64_tr_b16 v[80:81], v8 offset:8192
    v_mfma_f32_16x16x32_bf16 v[132:135], v[32:35], v[68:71], v[132:135]
    ds_read_b64_tr_b16 v[82:83], v8 offset:9216
    v_mfma_f32_16x16x32_bf16 v[136:139], v[32:35], v[72:75], v[136:139]
    ds_read_b128 v[112:115], v13 offset:0
    v_mfma_f32_16x16x32_bf16 v[140:143], v[32:35], v[76:79], v[140:143]
    ds_read_b128 v[116:119], v13 offset:2048
    v_mfma_f32_16x16x32_bf16 v[156:159], v[36:39], v[76:79], v[156:159]
    ds_read_b128 v[120:123], v13 offset:4096
    v_mfma_f32_16x16x32_bf16 v[152:155], v[36:39], v[72:75], v[152:155]
    ds_read_b128 v[124:127], v13 offset:6144
    v_mfma_f32_16x16x32_bf16 v[148:151], v[36:39], v[68:71], v[148:151]
    ds_read_b64_tr_b16 v[84:85], v9 offset:8192
    v_mfma_f32_16x16x32_bf16 v[144:147], v[36:39], v[64:67], v[144:147]
    ds_read_b64_tr_b16 v[86:87], v9 offset:9216
    v_mfma_f32_16x16x32_bf16 v[160:163], v[40:43], v[64:67], v[160:163]
    ds_read_b64_tr_b16 v[88:89], v10 offset:8192
    v_mfma_f32_16x16x32_bf16 v[164:167], v[40:43], v[68:71], v[164:167]
    ds_read_b64_tr_b16 v[90:91], v10 offset:9216
    v_mfma_f32_16x16x32_bf16 v[168:171], v[40:43], v[72:75], v[168:171]
    ds_read_b64_tr_b16 v[92:93], v11 offset:8192
    v_mfma_f32_16x16x32_bf16 v[172:175], v[40:43], v[76:79], v[172:175]
    ds_read_b64_tr_b16 v[94:95], v11 offset:9216
    v_mfma_f32_16x16x32_bf16 v[188:191], v[44:47], v[76:79], v[188:191]
    ds_read_b64_tr_b16 v[96:97], v8 offset:24576
    v_mfma_f32_16x16x32_bf16 v[184:187], v[44:47], v[72:75], v[184:187]
    ds_read_b64_tr_b16 v[98:99], v8 offset:25600
    v_mfma_f32_16x16x32_bf16 v[180:183], v[44:47], v[68:71], v[180:183]
    ds_read_b64_tr_b16 v[100:101], v9 offset:24576
    v_mfma_f32_16x16x32_bf16 v[176:179], v[44:47], v[64:67], v[176:179]
    ds_read_b64_tr_b16 v[102:103], v9 offset:25600
    v_mfma_f32_16x16x32_bf16 v[192:195], v[48:51], v[64:67], v[192:195]
    ds_read_b64_tr_b16 v[104:105], v10 offset:24576
    v_mfma_f32_16x16x32_bf16 v[196:199], v[48:51], v[68:71], v[196:199]
    ds_read_b64_tr_b16 v[106:107], v10 offset:25600
    v_mfma_f32_16x16x32_bf16 v[200:203], v[48:51], v[72:75], v[200:203]
    ds_read_b64_tr_b16 v[108:109], v11 offset:24576
    v_mfma_f32_16x16x32_bf16 v[204:207], v[48:51], v[76:79], v[204:207]
    ds_read_b64_tr_b16 v[110:111], v11 offset:25600
    v_mfma_f32_16x16x32_bf16 v[220:223], v[52:55], v[76:79], v[220:223]
    ds_read2_b32 v[14:15], v6 offset0:3 offset1:6
    v_mfma_f32_16x16x32_bf16 v[216:219], v[52:55], v[72:75], v[216:219]
    s_add_u32 s46, s46, 1
    v_mfma_f32_16x16x32_bf16 v[212:215], v[52:55], v[68:71], v[212:215]
    s_cmp_eq_u32 s46, 3
    v_mfma_f32_16x16x32_bf16 v[208:211], v[52:55], v[64:67], v[208:211]
    s_cselect_b32 s42, s50, s51
    v_mfma_f32_16x16x32_bf16 v[224:227], v[56:59], v[64:67], v[224:227]
    s_cselect_b32 s46, 0, s46
    v_mfma_f32_16x16x32_bf16 v[228:231], v[56:59], v[68:71], v[228:231]
    v_add_u32 v8, s42, v8
    v_mfma_f32_16x16x32_bf16 v[232:235], v[56:59], v[72:75], v[232:235]
    v_add_u32 v9, s42, v9
    v_mfma_f32_16x16x32_bf16 v[236:239], v[56:59], v[76:79], v[236:239]
    v_add_u32 v10, s42, v10
    v_mfma_f32_16x16x32_bf16 v[252:255], v[60:63], v[76:79], v[252:255]
    v_add_u32 v11, s42, v11
    v_mfma_f32_16x16x32_bf16 v[248:251], v[60:63], v[72:75], v[248:251]
    v_add_u32 v12, s42, v12
    v_mfma_f32_16x16x32_bf16 v[244:247], v[60:63], v[68:71], v[244:247]
    v_add_u32 v13, s42, v13
    v_mfma_f32_16x16x32_bf16 v[240:243], v[60:63], v[64:67], v[240:243]
    s_waitcnt vmcnt(0) lgkmcnt(0)
    s_cmp_ge_u32 s47, 8
    s_cbranch_scc1 L_ms_12_t
    s_barrier
L_ms_12_b:
    v_mfma_f32_16x16x32_bf16 v[128:131], v[80:83], v[112:115], v[128:131]
    ds_read_b64_tr_b16 v[32:33], v8 offset:0
    v_mfma_f32_16x16x32_bf16 v[132:135], v[80:83], v[116:119], v[132:135]
    ds_read_b64_tr_b16 v[34:35], v8 offset:1024
    v_mfma_f32_16x16x32_bf16 v[136:139], v[80:83], v[120:123], v[136:139]
    ds_read_b128 v[64:67], v12 offset:0
    v_mfma_f32_16x16x32_bf16 v[140:143], v[80:83], v[124:127], v[140:143]
    ds_read_b128 v[68:71], v12 offset:2048
    v_mfma_f32_16x16x32_bf16 v[156:159], v[84:87], v[124:127], v[156:159]
    ds_read_b128 v[72:75], v12 offset:4096
    v_mfma_f32_16x16x32_bf16 v[152:155], v[84:87], v[120:123], v[152:155]
    ds_read_b128 v[76:79], v12 offset:6144
    v_mfma_f32_16x16x32_bf16 v[148:151], v[84:87], v[116:119], v[148:151]
    ds_read_b64_tr_b16 v[36:37], v9 offset:0
    v_mfma_f32_16x16x32_bf16 v[144:147], v[84:87], v[112:115], v[144:147]
    ds_read_b64_tr_b16 v[38:39], v9 offset:1024
    v_mfma_f32_16x16x32_bf16 v[160:163], v[88:91], v[112:115], v[160:163]
    ds_read_b64_tr_b16 v[40:41], v10 offset:0
    v_mfma_f32_16x16x32_bf16 v[164:167], v[88:91], v[116:119], v[164:167]
    ds_read_b64_tr_b16 v[42:43], v10 offset:1024
    v_mfma_f32_16x16x32_bf16 v[168:171], v[88:91], v[120:123], v[168:171]
    ds_read_b64_tr_b16 v[44:45], v11 offset:0
    v_mfma_f32_16x16x32_bf16 v[172:175], v[88:91], v[124:127], v[172:175]
    ds_read_b64_tr_b16 v[46:47], v11 offset:1024
    v_mfma_f32_16x16x32_bf16 v[188:191], v[92:95], v[124:127], v[188:191]
    ds_read_b64_tr_b16 v[48:49], v8 offset:16384
    v_mfma_f32_16x16x32_bf16 v[184:187], v[92:95], v[120:123], v[184:187]
    ds_read_b64_tr_b16 v[50:51], v8 offset:17408
    v_mfma_f32_16x16x32_bf16 v[180:183], v[92:95], v[116:119], v[180:183]
    ds_read_b64_tr_b16 v[52:53], v9 offset:16384
    v_mfma_f32_16x16x32_bf16 v[176:179], v[92:95], v[112:115], v[176:179]
    ds_read_b64_tr_b16 v[54:55], v9 offset:17408
    v_mfma_f32_16x16x32_bf16 v[192:195], v[96:99], v[112:115], v[192:195]
    ds_read_b64_tr_b16 v[56:57], v10 offset:16384
    v_mfma_f32_16x16x32_bf16 v[196:199], v[96:99], v[116:119], v[196:199]
    ds_read_b64_tr_b16 v[58:59], v10 offset:17408
    v_mfma_f32_16x16x32_bf16 v[200:203], v[96:99], v[120:123], v[200:203]
    ds_read_b64_tr_b16 v[60:61], v11 offset:16384
    v_mfma_f32_16x16x32_bf16 v[204:207], v[96:99], v[124:127], v[204:207]
    ds_read_b64_tr_b16 v[62:63], v11 offset:17408
    v_mfma_f32_16x16x32_bf16 v[220:223], v[100:103], v[124:127], v[220:223]
    s_add_u32 s47, s47, 1
    v_mfma_f32_16x16x32_bf16 v[216:219], v[100:103], v[120:123], v[216:219]
    v_mfma_f32_16x16x32_bf16 v[212:215], v[100:103], v[116:119], v[212:215]
    v_mfma_f32_16x16x32_bf16 v[208:211], v[100:103], v[112:115], v[208:211]
    v_mfma_f32_16x16x32_bf16 v[224:227], v[104:107], v[112:115], v[224:227]
    v_mfma_f32_16x16x32_bf16 v[228:231], v[104:107], v[116:119], v[228:231]
    v_mfma_f32_16x16x32_bf16 v[232:235], v[104:107], v[120:123], v[232:235]
    v_mfma_f32_16x16x32_bf16 v[236:239], v[104:107], v[124:127], v[236:239]
    v_mfma_f32_16x16x32_bf16 v[252:255], v[108:111], v[124:127], v[252:255]
    v_mfma_f32_16x16x32_bf16 v[248:251], v[108:111], v[120:123], v[248:251]
    v_mfma_f32_16x16x32_bf16 v[244:247], v[108:111], v[116:119], v[244:247]
    v_mfma_f32_16x16x32_bf16 v[240:243], v[108:111], v[112:115], v[240:243]
    s_branch L_floop
L_ms_12_t:
    s_mov_b64 exec, 1
    s_cmp_eq_u32 s47, 9
    s_cbranch_scc1 L_ms_12_9
    ds_add_u32 v6, v5 offset:16
    s_mov_b64 exec, -1
    v_readfirstlane_b32 s78, v14
    s_cmp_ge_u32 s78, 3
    s_cbranch_scc1 L_ms_12_b
    v_mov_b32 v14, 149504
    s_mov_b32 s100, 0
L_ms_12_w:
    ds_read_b32 v15, v14 offset:12
    s_waitcnt lgkmcnt(0)
    v_readfirstlane_b32 s78, v15
    s_cmp_lt_u32 s78, 3
    s_cbranch_scc0 L_ms_12_w_ok
    s_add_u32 s100, s100, 1
    s_cmp_lt_u32 s100, 8388608
    s_sleep 3
    s_cbranch_scc1 L_ms_12_w
L_ms_12_w_ok:
    s_branch L_ms_12_b
L_ms_12_9:
    ds_add_u32 v6, v5 offset:20
    s_mov_b64 exec, -1
    s_branch L_flast
L_flast:
    buffer_load_dwordx4 v[32:35], v17, s[4:7], 0 offen
    buffer_load_dwordx4 v[36:39], v20, s[4:7], 0 offen
    buffer_load_dwordx4 v[28:31], v23, s[4:7], 0 offen
    v_readfirstlane_b32 s78, v15
    s_cmp_ge_u32 s78, 1
    s_cbranch_scc1 L_fst_ok
    v_mov_b32 v14, 149504
    s_mov_b32 s100, 0
L_fst:
    ds_read_b32 v15, v14 offset:24
    s_waitcnt lgkmcnt(0)
    v_readfirstlane_b32 s78, v15
    s_cmp_lt_u32 s78, 1
    s_cbranch_scc0 L_fst_ok
    s_add_u32 s100, s100, 1
    s_cmp_lt_u32 s100, 8388608
    s_sleep 3
    s_cbranch_scc1 L_fst
L_fst_ok:
    v_mfma_f32_16x16x32_bf16 v[128:131], v[80:83], v[112:115], v[128:131]
    s_lshl_b32 s66, s45, 8
    s_add_u32 s66, s66, 147456
    v_mfma_f32_16x16x32_bf16 v[132:135], v[80:83], v[116:119], v[132:135]
    v_lshlrev_b32 v4, 2, v3
    v_add_u32 v4, s66, v4
    v_mfma_f32_16x16x32_bf16 v[136:139], v[80:83], v[120:123], v[136:139]
    ds_read_b32 v40, v4 offset:0
    ds_read_b32 v44, v4 offset:512
    v_mfma_f32_16x16x32_bf16 v[140:143], v[80:83], v[124:127], v[140:143]
    ds_read_b32 v41, v4 offset:64
    ds_read_b32 v45, v4 offset:576
    v_mfma_f32_16x16x32_bf16 v[156:159], v[84:87], v[124:127], v[156:159]
    ds_read_b32 v42, v4 offset:128
    ds_read_b32 v46, v4 offset:640
    v_mfma_f32_16x16x32_bf16 v[152:155], v[84:87], v[120:123], v[152:155]
    ds_read_b32 v43, v4 offset:192
    ds_read_b32 v47, v4 offset:704
    v_mfma_f32_16x16x32_bf16 v[148:151], v[84:87], v[116:119], v[148:151]
    v_mov_b32 v10, 149504
    ds_read_b32 v8, v10 offset:32
    v_mfma_f32_16x16x32_bf16 v[144:147], v[84:87], v[112:115], v[144:147]
    ds_read_b32 v11, v10 offset:48
    s_lshl_b32 s66, s44, 8
    v_mfma_f32_16x16x32_bf16 v[160:163], v[88:91], v[112:115], v[160:163]
    s_add_u32 s66, s66, 148480
    v_lshlrev_b32 v5, 4, v2
    v_mfma_f32_16x16x32_bf16 v[164:167], v[88:91], v[116:119], v[164:167]
    v_add_u32 v5, s66, v5
    ds_read_b128 v[48:51], v5 offset:0
    v_mfma_f32_16x16x32_bf16 v[168:171], v[88:91], v[120:123], v[168:171]
    ds_read_b128 v[52:55], v5 offset:64
    ds_read_b128 v[56:59], v5 offset:128
    v_mfma_f32_16x16x32_bf16 v[172:175], v[88:91], v[124:127], v[172:175]
    ds_read_b128 v[60:63], v5 offset:192
    ds_read_b128 v[64:67], v5 offset:512
    v_mfma_f32_16x16x32_bf16 v[188:191], v[92:95], v[124:127], v[188:191]
    ds_read_b128 v[68:71], v5 offset:576
    ds_read_b128 v[72:75], v5 offset:640
    v_mfma_f32_16x16x32_bf16 v[184:187], v[92:95], v[120:123], v[184:187]
    ds_read_b128 v[76:79], v5 offset:704
    v_lshlrev_b32 v1, 4, v0
    v_mfma_f32_16x16x32_bf16 v[180:183], v[92:95], v[116:119], v[180:183]
    v_mov_b32 v9, 0
    s_lshl_b32 s66, s28, 3
    v_mfma_f32_16x16x32_bf16 v[176:179], v[92:95], v[112:115], v[176:179]
    s_lshl_b32 s67, s45, 2
    s_add_u32 s66, s66, s67
    v_mfma_f32_16x16x32_bf16 v[192:195], v[96:99], v[112:115], v[192:195]
    s_mul_i32 s66, s66, 48
    s_lshl_b32 s67, s29, 2
    v_mfma_f32_16x16x32_bf16 v[196:199], v[96:99], v[116:119], v[196:199]
    s_add_u32 s66, s66, s67
    s_lshl_b32 s67, s44, 1
    v_mfma_f32_16x16x32_bf16 v[200:203], v[96:99], v[120:123], v[200:203]
    s_add_u32 s66, s66, s67
    s_lshl_b32 s66, s66, 10
    v_mfma_f32_16x16x32_bf16 v[204:207], v[96:99], v[124:127], v[204:207]
    s_lshl_b32 s70, s28, 8
    s_lshl_b32 s71, s29, 4
    v_mfma_f32_16x16x32_bf16 v[220:223], v[100:103], v[124:127], v[220:223]
    s_add_u32 s70, s70, s71
    s_lshl_b32 s71, s3, 2
    v_mfma_f32_16x16x32_bf16 v[216:219], v[100:103], v[120:123], v[216:219]
    s_add_u32 s70, s70, s71
    s_add_u32 s70, s70, 11735040
    v_mfma_f32_16x16x32_bf16 v[212:215], v[100:103], v[116:119], v[212:215]
    v_mfma_f32_16x16x32_bf16 v[208:211], v[100:103], v[112:115], v[208:211]
    v_mfma_f32_16x16x32_bf16 v[224:227], v[104:107], v[112:115], v[224:227]
    v_mfma_f32_16x16x32_bf16 v[228:231], v[104:107], v[116:119], v[228:231]
    v_mfma_f32_16x16x32_bf16 v[232:235], v[104:107], v[120:123], v[232:235]
    v_mfma_f32_16x16x32_bf16 v[236:239], v[104:107], v[124:127], v[236:239]
    v_mfma_f32_16x16x32_bf16 v[252:255], v[108:111], v[124:127], v[252:255]
    v_mfma_f32_16x16x32_bf16 v[248:251], v[108:111], v[120:123], v[248:251]
    v_mfma_f32_16x16x32_bf16 v[244:247], v[108:111], v[116:119], v[244:247]
    v_mfma_f32_16x16x32_bf16 v[240:243], v[108:111], v[112:115], v[240:243]
    s_waitcnt lgkmcnt(0)
    v_readfirstlane_b32 s43, v8
    v_sub_f32 v80, 0, v44
    v_mul_f32 v82, -1.4426950408889634, v40
    v_mul_f32 v84, v40, v40
    v_sub_f32 v86, 0, v45
    v_mul_f32 v88, -1.4426950408889634, v41
    v_mul_f32 v90, v41, v41
    v_sub_f32 v92, 0, v46
    v_mul_f32 v94, -1.4426950408889634, v42
    v_mul_f32 v96, v42, v42
    v_sub_f32 v98, 0, v47
    v_mul_f32 v100, -1.4426950408889634, v43
    v_mul_f32 v102, v43, v43
    v_rcp_f32 v84, v84
    v_rcp_f32 v90, v90
    v_rcp_f32 v96, v96
    v_rcp_f32 v102, v102
    s_add_u32 s67, s66, 49152
    s_add_u32 s68, s67, 49152
    s_add_u32 s69, s68, 49152
    v_pk_fma_f32 v[128:129], v[48:49], v[80:81], v[128:129] op_sel_hi:[1,0,1]
    v_pk_fma_f32 v[130:131], v[50:51], v[80:81], v[130:131] op_sel_hi:[1,0,1]
    v_pk_fma_f32 v[144:145], v[52:53], v[80:81], v[144:145] op_sel_hi:[1,0,1]
    v_pk_fma_f32 v[146:147], v[54:55], v[80:81], v[146:147] op_sel_hi:[1,0,1]
    v_pk_fma_f32 v[192:193], v[64:65], v[80:81], v[192:193] op_sel_hi:[1,0,1]
    v_pk_fma_f32 v[194:195], v[66:67], v[80:81], v[194:195] op_sel_hi:[1,0,1]
    v_pk_fma_f32 v[208:209], v[68:69], v[80:81], v[208:209] op_sel_hi:[1,0,1]
    v_pk_fma_f32 v[210:211], v[70:71], v[80:81], v[210:211] op_sel_hi:[1,0,1]
    v_pk_mul_f32 v[104:105], v[128:129], v[82:83] op_sel_hi:[1,0]
    v_pk_mul_f32 v[106:107], v[130:131], v[82:83] op_sel_hi:[1,0]
    v_pk_mul_f32 v[108:109], v[144:145], v[82:83] op_sel_hi:[1,0]
    v_pk_mul_f32 v[110:111], v[146:147], v[82:83] op_sel_hi:[1,0]
    v_pk_mul_f32 v[128:129], v[128:129], v[192:193]
    v_pk_mul_f32 v[130:131], v[130:131], v[194:195]
    v_pk_mul_f32 v[144:145], v[144:145], v[208:209]
    v_pk_mul_f32 v[146:147], v[146:147], v[210:211]
    v_exp_f32 v104, v104
    v_exp_f32 v105, v105
    v_exp_f32 v106, v106
    v_exp_f32 v107, v107
    v_exp_f32 v108, v108
    v_exp_f32 v109, v109
    v_exp_f32 v110, v110
    v_exp_f32 v111, v111
    s_nop 0
    v_pk_fma_f32 v[104:105], v[104:105], v[84:85], v[84:85] op_sel_hi:[1,0,0]
    v_pk_fma_f32 v[106:107], v[106:107], v[84:85], v[84:85] op_sel_hi:[1,0,0]
    v_pk_fma_f32 v[108:109], v[108:109], v[84:85], v[84:85] op_sel_hi:[1,0,0]
    v_pk_fma_f32 v[110:111], v[110:111], v[84:85], v[84:85] op_sel_hi:[1,0,0]
    v_rcp_f32 v104, v104
    v_rcp_f32 v105, v105
    v_rcp_f32 v106, v106
    v_rcp_f32 v107, v107
    v_rcp_f32 v108, v108
    v_rcp_f32 v109, v109
    v_rcp_f32 v110, v110
    v_rcp_f32 v111, v111
    s_nop 0
    v_pk_mul_f32 v[128:129], v[128:129], v[104:105]
    v_pk_mul_f32 v[130:131], v[130:131], v[106:107]
    v_pk_mul_f32 v[144:145], v[144:145], v[108:109]
    v_pk_mul_f32 v[146:147], v[146:147], v[110:111]
    v_cvt_pk_bf16_f32 v112, v128, v129
    v_cvt_pk_bf16_f32 v113, v130, v131
    v_cvt_pk_bf16_f32 v114, v144, v145
    v_cvt_pk_bf16_f32 v115, v146, v147
    v_readfirstlane_b32 s78, v11
    s_cmp_ge_u32 s78, 1
    s_cbranch_scc1 L_frw_ok
    v_mov_b32 v14, 149504
    s_mov_b32 s100, 0
L_frw:
    ds_read_b32 v15, v14 offset:48
    s_waitcnt lgkmcnt(0)
    v_readfirstlane_b32 s78, v15
    s_cmp_lt_u32 s78, 1
    s_cbranch_scc0 L_frw_ok
    s_add_u32 s100, s100, 1
    s_cmp_lt_u32 s100, 8388608
    s_sleep 3
    s_cbranch_scc1 L_frw
L_frw_ok:
    buffer_store_dwordx4 v[112:115], v1, s[12:15], s66 offen offset:0 sc1
    v_pk_fma_f32 v[132:133], v[48:49], v[86:87], v[132:133] op_sel_hi:[1,0,1]
    v_pk_fma_f32 v[134:135], v[50:51], v[86:87], v[134:135] op_sel_hi:[1,0,1]
    v_pk_fma_f32 v[148:149], v[52:53], v[86:87], v[148:149] op_sel_hi:[1,0,1]
    v_pk_fma_f32 v[150:151], v[54:55], v[86:87], v[150:151] op_sel_hi:[1,0,1]
    v_pk_fma_f32 v[196:197], v[64:65], v[86:87], v[196:197] op_sel_hi:[1,0,1]
    v_pk_fma_f32 v[198:199], v[66:67], v[86:87], v[198:199] op_sel_hi:[1,0,1]
    v_pk_fma_f32 v[212:213], v[68:69], v[86:87], v[212:213] op_sel_hi:[1,0,1]
    v_pk_fma_f32 v[214:215], v[70:71], v[86:87], v[214:215] op_sel_hi:[1,0,1]
    v_pk_mul_f32 v[104:105], v[132:133], v[88:89] op_sel_hi:[1,0]
    v_pk_mul_f32 v[106:107], v[134:135], v[88:89] op_sel_hi:[1,0]
    v_pk_mul_f32 v[108:109], v[148:149], v[88:89] op_sel_hi:[1,0]
    v_pk_mul_f32 v[110:111], v[150:151], v[88:89] op_sel_hi:[1,0]
    v_pk_mul_f32 v[132:133], v[132:133], v[196:197]
    v_pk_mul_f32 v[134:135], v[134:135], v[198:199]
    v_pk_mul_f32 v[148:149], v[148:149], v[212:213]
    v_pk_mul_f32 v[150:151], v[150:151], v[214:215]
    v_exp_f32 v104, v104
    v_exp_f32 v105, v105
    v_exp_f32 v106, v106
    v_exp_f32 v107, v107
    v_exp_f32 v108, v108
    v_exp_f32 v109, v109
    v_exp_f32 v110, v110
    v_exp_f32 v111, v111
    s_nop 0
    v_pk_fma_f32 v[104:105], v[104:105], v[90:91], v[90:91] op_sel_hi:[1,0,0]
    v_pk_fma_f32 v[106:107], v[106:107], v[90:91], v[90:91] op_sel_hi:[1,0,0]
    v_pk_fma_f32 v[108:109], v[108:109], v[90:91], v[90:91] op_sel_hi:[1,0,0]
    v_pk_fma_f32 v[110:111], v[110:111], v[90:91], v[90:91] op_sel_hi:[1,0,0]
    v_rcp_f32 v104, v104
    v_rcp_f32 v105, v105
    v_rcp_f32 v106, v106
    v_rcp_f32 v107, v107
    v_rcp_f32 v108, v108
    v_rcp_f32 v109, v109
    v_rcp_f32 v110, v110
    v_rcp_f32 v111, v111
    s_nop 0
    v_pk_mul_f32 v[132:133], v[132:133], v[104:105]
    v_pk_mul_f32 v[134:135], v[134:135], v[106:107]
    v_pk_mul_f32 v[148:149], v[148:149], v[108:109]
    v_pk_mul_f32 v[150:151], v[150:151], v[110:111]
    v_cvt_pk_bf16_f32 v116, v132, v133
    v_cvt_pk_bf16_f32 v117, v134, v135
    v_cvt_pk_bf16_f32 v118, v148, v149
    v_cvt_pk_bf16_f32 v119, v150, v151
    buffer_store_dwordx4 v[116:119], v1, s[12:15], s67 offen offset:0 sc1
    v_pk_fma_f32 v[136:137], v[48:49], v[92:93], v[136:137] op_sel_hi:[1,0,1]
    v_pk_fma_f32 v[138:139], v[50:51], v[92:93], v[138:139] op_sel_hi:[1,0,1]
    v_pk_fma_f32 v[152:153], v[52:53], v[92:93], v[152:153] op_sel_hi:[1,0,1]
    v_pk_fma_f32 v[154:155], v[54:55], v[92:93], v[154:155] op_sel_hi:[1,0,1]
    v_pk_fma_f32 v[200:201], v[64:65], v[92:93], v[200:201] op_sel_hi:[1,0,1]
    v_pk_fma_f32 v[202:203], v[66:67], v[92:93], v[202:203] op_sel_hi:[1,0,1]
    v_pk_fma_f32 v[216:217], v[68:69], v[92:93], v[216:217] op_sel_hi:[1,0,1]
    v_pk_fma_f32 v[218:219], v[70:71], v[92:93], v[218:219] op_sel_hi:[1,0,1]
    v_pk_mul_f32 v[104:105], v[136:137], v[94:95] op_sel_hi:[1,0]
    v_pk_mul_f32 v[106:107], v[138:139], v[94:95] op_sel_hi:[1,0]
    v_pk_mul_f32 v[108:109], v[152:153], v[94:95] op_sel_hi:[1,0]
    v_pk_mul_f32 v[110:111], v[154:155], v[94:95] op_sel_hi:[1,0]
    v_pk_mul_f32 v[136:137], v[136:137], v[200:201]
    v_pk_mul_f32 v[138:139], v[138:139], v[202:203]
    v_pk_mul_f32 v[152:153], v[152:153], v[216:217]
    v_pk_mul_f32 v[154:155], v[154:155], v[218:219]
    v_exp_f32 v104, v104
    v_exp_f32 v105, v105
    v_exp_f32 v106, v106
    v_exp_f32 v107, v107
    v_exp_f32 v108, v108
    v_exp_f32 v109, v109
    v_exp_f32 v110, v110
    v_exp_f32 v111, v111
    s_nop 0
    v_pk_fma_f32 v[104:105], v[104:105], v[96:97], v[96:97] op_sel_hi:[1,0,0]
    v_pk_fma_f32 v[106:107], v[106:107], v[96:97], v[96:97] op_sel_hi:[1,0,0]
    v_pk_fma_f32 v[108:109], v[108:109], v[96:97], v[96:97] op_sel_hi:[1,0,0]
    v_pk_fma_f32 v[110:111], v[110:111], v[96:97], v[96:97] op_sel_hi:[1,0,0]
    v_rcp_f32 v104, v104
    v_rcp_f32 v105, v105
    v_rcp_f32 v106, v106
    v_rcp_f32 v107, v107
    v_rcp_f32 v108, v108
    v_rcp_f32 v109, v109
    v_rcp_f32 v110, v110
    v_rcp_f32 v111, v111
    s_nop 0
    v_pk_mul_f32 v[136:137], v[136:137], v[104:105]
    v_pk_mul_f32 v[138:139], v[138:139], v[106:107]
    v_pk_mul_f32 v[152:153], v[152:153], v[108:109]
    v_pk_mul_f32 v[154:155], v[154:155], v[110:111]
    v_cvt_pk_bf16_f32 v120, v136, v137
    v_cvt_pk_bf16_f32 v121, v138, v139
    v_cvt_pk_bf16_f32 v122, v152, v153
    v_cvt_pk_bf16_f32 v123, v154, v155
    buffer_store_dwordx4 v[120:123], v1, s[12:15], s68 offen offset:0 sc1
    v_pk_fma_f32 v[140:141], v[48:49], v[98:99], v[140:141] op_sel_hi:[1,0,1]
    v_pk_fma_f32 v[142:143], v[50:51], v[98:99], v[142:143] op_sel_hi:[1,0,1]
    v_pk_fma_f32 v[156:157], v[52:53], v[98:99], v[156:157] op_sel_hi:[1,0,1]
    v_pk_fma_f32 v[158:159], v[54:55], v[98:99], v[158:159] op_sel_hi:[1,0,1]
    v_pk_fma_f32 v[204:205], v[64:65], v[98:99], v[204:205] op_sel_hi:[1,0,1]
    v_pk_fma_f32 v[206:207], v[66:67], v[98:99], v[206:207] op_sel_hi:[1,0,1]
    v_pk_fma_f32 v[220:221], v[68:69], v[98:99], v[220:221] op_sel_hi:[1,0,1]
    v_pk_fma_f32 v[222:223], v[70:71], v[98:99], v[222:223] op_sel_hi:[1,0,1]
    v_pk_mul_f32 v[104:105], v[140:141], v[100:101] op_sel_hi:[1,0]
    v_pk_mul_f32 v[106:107], v[142:143], v[100:101] op_sel_hi:[1,0]
    v_pk_mul_f32 v[108:109], v[156:157], v[100:101] op_sel_hi:[1,0]
    v_pk_mul_f32 v[110:111], v[158:159], v[100:101] op_sel_hi:[1,0]
    v_pk_mul_f32 v[140:141], v[140:141], v[204:205]
    v_pk_mul_f32 v[142:143], v[142:143], v[206:207]
    v_pk_mul_f32 v[156:157], v[156:157], v[220:221]
    v_pk_mul_f32 v[158:159], v[158:159], v[222:223]
    v_exp_f32 v104, v104
    v_exp_f32 v105, v105
    v_exp_f32 v106, v106
    v_exp_f32 v107, v107
    v_exp_f32 v108, v108
    v_exp_f32 v109, v109
    v_exp_f32 v110, v110
    v_exp_f32 v111, v111
    s_nop 0
    v_pk_fma_f32 v[104:105], v[104:105], v[102:103], v[102:103] op_sel_hi:[1,0,0]
    v_pk_fma_f32 v[106:107], v[106:107], v[102:103], v[102:103] op_sel_hi:[1,0,0]
    v_pk_fma_f32 v[108:109], v[108:109], v[102:103], v[102:103] op_sel_hi:[1,0,0]
    v_pk_fma_f32 v[110:111], v[110:111], v[102:103], v[102:103] op_sel_hi:[1,0,0]
    v_rcp_f32 v104, v104
    v_rcp_f32 v105, v105
    v_rcp_f32 v106, v106
    v_rcp_f32 v107, v107
    v_rcp_f32 v108, v108
    v_rcp_f32 v109, v109
    v_rcp_f32 v110, v110
    v_rcp_f32 v111, v111
    s_nop 0
    v_pk_mul_f32 v[140:141], v[140:141], v[104:105]
    v_pk_mul_f32 v[142:143], v[142:143], v[106:107]
    v_pk_mul_f32 v[156:157], v[156:157], v[108:109]
    v_pk_mul_f32 v[158:159], v[158:159], v[110:111]
    v_cvt_pk_bf16_f32 v124, v140, v141
    v_cvt_pk_bf16_f32 v125, v142, v143
    v_cvt_pk_bf16_f32 v126, v156, v157
    v_cvt_pk_bf16_f32 v127, v158, v159
    buffer_store_dwordx4 v[124:127], v1, s[12:15], s69 offen offset:0 sc1
    v_pk_fma_f32 v[160:161], v[56:57], v[80:81], v[160:161] op_sel_hi:[1,0,1]
    v_pk_fma_f32 v[162:163], v[58:59], v[80:81], v[162:163] op_sel_hi:[1,0,1]
    v_pk_fma_f32 v[176:177], v[60:61], v[80:81], v[176:177] op_sel_hi:[1,0,1]
    v_pk_fma_f32 v[178:179], v[62:63], v[80:81], v[178:179] op_sel_hi:[1,0,1]
    v_pk_fma_f32 v[224:225], v[72:73], v[80:81], v[224:225] op_sel_hi:[1,0,1]
    v_pk_fma_f32 v[226:227], v[74:75], v[80:81], v[226:227] op_sel_hi:[1,0,1]
    v_pk_fma_f32 v[240:241], v[76:77], v[80:81], v[240:241] op_sel_hi:[1,0,1]
    v_pk_fma_f32 v[242:243], v[78:79], v[80:81], v[242:243] op_sel_hi:[1,0,1]
    v_pk_mul_f32 v[104:105], v[160:161], v[82:83] op_sel_hi:[1,0]
    v_pk_mul_f32 v[106:107], v[162:163], v[82:83] op_sel_hi:[1,0]
    v_pk_mul_f32 v[108:109], v[176:177], v[82:83] op_sel_hi:[1,0]
    v_pk_mul_f32 v[110:111], v[178:179], v[82:83] op_sel_hi:[1,0]
    v_pk_mul_f32 v[160:161], v[160:161], v[224:225]
    v_pk_mul_f32 v[162:163], v[162:163], v[226:227]
    v_pk_mul_f32 v[176:177], v[176:177], v[240:241]
    v_pk_mul_f32 v[178:179], v[178:179], v[242:243]
    v_exp_f32 v104, v104
    v_exp_f32 v105, v105
    v_exp_f32 v106, v106
    v_exp_f32 v107, v107
    v_exp_f32 v108, v108
    v_exp_f32 v109, v109
    v_exp_f32 v110, v110
    v_exp_f32 v111, v111
    s_nop 0
    v_pk_fma_f32 v[104:105], v[104:105], v[84:85], v[84:85] op_sel_hi:[1,0,0]
    v_pk_fma_f32 v[106:107], v[106:107], v[84:85], v[84:85] op_sel_hi:[1,0,0]
    v_pk_fma_f32 v[108:109], v[108:109], v[84:85], v[84:85] op_sel_hi:[1,0,0]
    v_pk_fma_f32 v[110:111], v[110:111], v[84:85], v[84:85] op_sel_hi:[1,0,0]
    v_rcp_f32 v104, v104
    v_rcp_f32 v105, v105
    v_rcp_f32 v106, v106
    v_rcp_f32 v107, v107
    v_rcp_f32 v108, v108
    v_rcp_f32 v109, v109
    v_rcp_f32 v110, v110
    v_rcp_f32 v111, v111
    s_nop 0
    v_pk_mul_f32 v[160:161], v[160:161], v[104:105]
    v_pk_mul_f32 v[162:163], v[162:163], v[106:107]
    v_pk_mul_f32 v[176:177], v[176:177], v[108:109]
    v_pk_mul_f32 v[178:179], v[178:179], v[110:111]
    v_cvt_pk_bf16_f32 v112, v160, v161
    v_cvt_pk_bf16_f32 v113, v162, v163
    v_cvt_pk_bf16_f32 v114, v176, v177
    v_cvt_pk_bf16_f32 v115, v178, v179
    buffer_store_dwordx4 v[112:115], v1, s[12:15], s66 offen offset:1024 sc1
    v_pk_fma_f32 v[164:165], v[56:57], v[86:87], v[164:165] op_sel_hi:[1,0,1]
    v_pk_fma_f32 v[166:167], v[58:59], v[86:87], v[166:167] op_sel_hi:[1,0,1]
    v_pk_fma_f32 v[180:181], v[60:61], v[86:87], v[180:181] op_sel_hi:[1,0,1]
    v_pk_fma_f32 v[182:183], v[62:63], v[86:87], v[182:183] op_sel_hi:[1,0,1]
    v_pk_fma_f32 v[228:229], v[72:73], v[86:87], v[228:229] op_sel_hi:[1,0,1]
    v_pk_fma_f32 v[230:231], v[74:75], v[86:87], v[230:231] op_sel_hi:[1,0,1]
    v_pk_fma_f32 v[244:245], v[76:77], v[86:87], v[244:245] op_sel_hi:[1,0,1]
    v_pk_fma_f32 v[246:247], v[78:79], v[86:87], v[246:247] op_sel_hi:[1,0,1]
    v_pk_mul_f32 v[104:105], v[164:165], v[88:89] op_sel_hi:[1,0]
    v_pk_mul_f32 v[106:107], v[166:167], v[88:89] op_sel_hi:[1,0]
    v_pk_mul_f32 v[108:109], v[180:181], v[88:89] op_sel_hi:[1,0]
    v_pk_mul_f32 v[110:111], v[182:183], v[88:89] op_sel_hi:[1,0]
    v_pk_mul_f32 v[164:165], v[164:165], v[228:229]
    v_pk_mul_f32 v[166:167], v[166:167], v[230:231]
    v_pk_mul_f32 v[180:181], v[180:181], v[244:245]
    v_pk_mul_f32 v[182:183], v[182:183], v[246:247]
    v_exp_f32 v104, v104
    v_exp_f32 v105, v105
    v_exp_f32 v106, v106
    v_exp_f32 v107, v107
    v_exp_f32 v108, v108
    v_exp_f32 v109, v109
    v_exp_f32 v110, v110
    v_exp_f32 v111, v111
    s_nop 0
    v_pk_fma_f32 v[104:105], v[104:105], v[90:91], v[90:91] op_sel_hi:[1,0,0]
    v_pk_fma_f32 v[106:107], v[106:107], v[90:91], v[90:91] op_sel_hi:[1,0,0]
    v_pk_fma_f32 v[108:109], v[108:109], v[90:91], v[90:91] op_sel_hi:[1,0,0]
    v_pk_fma_f32 v[110:111], v[110:111], v[90:91], v[90:91] op_sel_hi:[1,0,0]
    v_rcp_f32 v104, v104
    v_rcp_f32 v105, v105
    v_rcp_f32 v106, v106
    v_rcp_f32 v107, v107
    v_rcp_f32 v108, v108
    v_rcp_f32 v109, v109
    v_rcp_f32 v110, v110
    v_rcp_f32 v111, v111
    s_nop 0
    v_pk_mul_f32 v[164:165], v[164:165], v[104:105]
    v_pk_mul_f32 v[166:167], v[166:167], v[106:107]
    v_pk_mul_f32 v[180:181], v[180:181], v[108:109]
    v_pk_mul_f32 v[182:183], v[182:183], v[110:111]
    v_cvt_pk_bf16_f32 v116, v164, v165
    v_cvt_pk_bf16_f32 v117, v166, v167
    v_cvt_pk_bf16_f32 v118, v180, v181
    v_cvt_pk_bf16_f32 v119, v182, v183
    buffer_store_dwordx4 v[116:119], v1, s[12:15], s67 offen offset:1024 sc1
    v_pk_fma_f32 v[168:169], v[56:57], v[92:93], v[168:169] op_sel_hi:[1,0,1]
    v_pk_fma_f32 v[170:171], v[58:59], v[92:93], v[170:171] op_sel_hi:[1,0,1]
    v_pk_fma_f32 v[184:185], v[60:61], v[92:93], v[184:185] op_sel_hi:[1,0,1]
    v_pk_fma_f32 v[186:187], v[62:63], v[92:93], v[186:187] op_sel_hi:[1,0,1]
    v_pk_fma_f32 v[232:233], v[72:73], v[92:93], v[232:233] op_sel_hi:[1,0,1]
    v_pk_fma_f32 v[234:235], v[74:75], v[92:93], v[234:235] op_sel_hi:[1,0,1]
    v_pk_fma_f32 v[248:249], v[76:77], v[92:93], v[248:249] op_sel_hi:[1,0,1]
    v_pk_fma_f32 v[250:251], v[78:79], v[92:93], v[250:251] op_sel_hi:[1,0,1]
    v_pk_mul_f32 v[104:105], v[168:169], v[94:95] op_sel_hi:[1,0]
    v_pk_mul_f32 v[106:107], v[170:171], v[94:95] op_sel_hi:[1,0]
    v_pk_mul_f32 v[108:109], v[184:185], v[94:95] op_sel_hi:[1,0]
    v_pk_mul_f32 v[110:111], v[186:187], v[94:95] op_sel_hi:[1,0]
    v_pk_mul_f32 v[168:169], v[168:169], v[232:233]
    v_pk_mul_f32 v[170:171], v[170:171], v[234:235]
    v_pk_mul_f32 v[184:185], v[184:185], v[248:249]
    v_pk_mul_f32 v[186:187], v[186:187], v[250:251]
    v_exp_f32 v104, v104
    v_exp_f32 v105, v105
    v_exp_f32 v106, v106
    v_exp_f32 v107, v107
    v_exp_f32 v108, v108
    v_exp_f32 v109, v109
    v_exp_f32 v110, v110
    v_exp_f32 v111, v111
    s_nop 0
    v_pk_fma_f32 v[104:105], v[104:105], v[96:97], v[96:97] op_sel_hi:[1,0,0]
    v_pk_fma_f32 v[106:107], v[106:107], v[96:97], v[96:97] op_sel_hi:[1,0,0]
    v_pk_fma_f32 v[108:109], v[108:109], v[96:97], v[96:97] op_sel_hi:[1,0,0]
    v_pk_fma_f32 v[110:111], v[110:111], v[96:97], v[96:97] op_sel_hi:[1,0,0]
    v_rcp_f32 v104, v104
    v_rcp_f32 v105, v105
    v_rcp_f32 v106, v106
    v_rcp_f32 v107, v107
    v_rcp_f32 v108, v108
    v_rcp_f32 v109, v109
    v_rcp_f32 v110, v110
    v_rcp_f32 v111, v111
    s_nop 0
    v_pk_mul_f32 v[168:169], v[168:169], v[104:105]
    v_pk_mul_f32 v[170:171], v[170:171], v[106:107]
    v_pk_mul_f32 v[184:185], v[184:185], v[108:109]
    v_pk_mul_f32 v[186:187], v[186:187], v[110:111]
    v_cvt_pk_bf16_f32 v120, v168, v169
    v_cvt_pk_bf16_f32 v121, v170, v171
    v_cvt_pk_bf16_f32 v122, v184, v185
    v_cvt_pk_bf16_f32 v123, v186, v187
    buffer_store_dwordx4 v[120:123], v1, s[12:15], s68 offen offset:1024 sc1
    ds_read_b32 v11, v10 offset:28
    v_pk_fma_f32 v[172:173], v[56:57], v[98:99], v[172:173] op_sel_hi:[1,0,1]
    v_pk_fma_f32 v[174:175], v[58:59], v[98:99], v[174:175] op_sel_hi:[1,0,1]
    v_pk_fma_f32 v[188:189], v[60:61], v[98:99], v[188:189] op_sel_hi:[1,0,1]
    v_pk_fma_f32 v[190:191], v[62:63], v[98:99], v[190:191] op_sel_hi:[1,0,1]
    v_pk_fma_f32 v[236:237], v[72:73], v[98:99], v[236:237] op_sel_hi:[1,0,1]
    v_pk_fma_f32 v[238:239], v[74:75], v[98:99], v[238:239] op_sel_hi:[1,0,1]
    v_pk_fma_f32 v[252:253], v[76:77], v[98:99], v[252:253] op_sel_hi:[1,0,1]
    v_pk_fma_f32 v[254:255], v[78:79], v[98:99], v[254:255] op_sel_hi:[1,0,1]
    v_pk_mul_f32 v[104:105], v[172:173], v[100:101] op_sel_hi:[1,0]
    v_pk_mul_f32 v[106:107], v[174:175], v[100:101] op_sel_hi:[1,0]
    v_pk_mul_f32 v[108:109], v[188:189], v[100:101] op_sel_hi:[1,0]
    v_pk_mul_f32 v[110:111], v[190:191], v[100:101] op_sel_hi:[1,0]
    v_pk_mul_f32 v[172:173], v[172:173], v[236:237]
    v_pk_mul_f32 v[174:175], v[174:175], v[238:239]
    v_pk_mul_f32 v[188:189], v[188:189], v[252:253]
    v_pk_mul_f32 v[190:191], v[190:191], v[254:255]
    v_exp_f32 v104, v104
    v_exp_f32 v105, v105
    v_exp_f32 v106, v106
    v_exp_f32 v107, v107
    v_exp_f32 v108, v108
    v_exp_f32 v109, v109
    v_exp_f32 v110, v110
    v_exp_f32 v111, v111
    s_nop 0
    v_pk_fma_f32 v[104:105], v[104:105], v[102:103], v[102:103] op_sel_hi:[1,0,0]
    v_pk_fma_f32 v[106:107], v[106:107], v[102:103], v[102:103] op_sel_hi:[1,0,0]
    v_pk_fma_f32 v[108:109], v[108:109], v[102:103], v[102:103] op_sel_hi:[1,0,0]
    v_pk_fma_f32 v[110:111], v[110:111], v[102:103], v[102:103] op_sel_hi:[1,0,0]
    v_rcp_f32 v104, v104
    v_rcp_f32 v105, v105
    v_rcp_f32 v106, v106
    v_rcp_f32 v107, v107
    v_rcp_f32 v108, v108
    v_rcp_f32 v109, v109
    v_rcp_f32 v110, v110
    v_rcp_f32 v111, v111
    s_nop 0
    v_pk_mul_f32 v[172:173], v[172:173], v[104:105]
    v_pk_mul_f32 v[174:175], v[174:175], v[106:107]
    v_pk_mul_f32 v[188:189], v[188:189], v[108:109]
    v_pk_mul_f32 v[190:191], v[190:191], v[110:111]
    v_cvt_pk_bf16_f32 v124, v172, v173
    v_cvt_pk_bf16_f32 v125, v174, v175
    v_cvt_pk_bf16_f32 v126, v188, v189
    v_cvt_pk_bf16_f32 v127, v190, v191
    s_waitcnt vmcnt(3)
    buffer_store_dwordx4 v[124:127], v1, s[12:15], s69 offen offset:1024 sc1
    s_waitcnt vmcnt(0)
    s_waitcnt lgkmcnt(0)
    v_readfirstlane_b32 s79, v11
    s_cmp_lg_u32 s79, 1
    s_cbranch_scc1 L_fnov
    s_mov_b32 s72, s56
    buffer_load_dwordx4 v[128:131], v25, s[12:15], s72 offen sc1
    s_add_u32 s72, s72, 178432
    buffer_load_dwordx4 v[132:135], v25, s[12:15], s72 offen sc1
    s_add_u32 s72, s72, 178432
    buffer_load_dwordx4 v[136:139], v25, s[12:15], s72 offen sc1
    s_add_u32 s72, s72, 178432
    buffer_load_dwordx4 v[140:143], v25, s[12:15], s72 offen sc1
    s_cmp_lg_u32 s3, 0
    s_cbranch_scc1 L_vl_13
    s_mov_b32 s72, s56
    buffer_load_dwordx4 v[144:147], v26, s[12:15], s72 offen sc1
    s_add_u32 s72, s72, 178432
    buffer_load_dwordx4 v[148:151], v26, s[12:15], s72 offen sc1
    s_add_u32 s72, s72, 178432
    buffer_load_dwordx4 v[152:155], v26, s[12:15], s72 offen sc1
    s_add_u32 s72, s72, 178432
    buffer_load_dwordx4 v[156:159], v26, s[12:15], s72 offen sc1
L_vl_13:
L_fnov:
    s_branch L_helper
L_dft:
    v_lshlrev_b32 v5, 7, v3
    s_lshl_b32 s66, s3, 12
    s_add_u32 s66, s66, 32768
    v_xor_b32 v7, 0, v6
    v_lshl_add_u32 v10, v7, 4, v5
    v_add_u32 v8, s66, v10
    v_xor_b32 v7, 4, v6
    v_lshl_add_u32 v11, v7, 4, v5
    v_add_u32 v9, s66, v11
    v_mov_b32 v176, 0
    v_mov_b32 v177, 0
    v_mov_b32 v178, 0
    v_mov_b32 v179, 0
    v_mov_b32 v180, 0
    v_mov_b32 v181, 0
    v_mov_b32 v182, 0
    v_mov_b32 v183, 0
    v_mov_b32 v184, 0
    v_mov_b32 v185, 0
    v_mov_b32 v186, 0
    v_mov_b32 v187, 0
    v_mov_b32 v188, 0
    v_mov_b32 v189, 0
    v_mov_b32 v190, 0
    v_mov_b32 v191, 0
    v_mov_b32 v192, 0
    v_mov_b32 v193, 0
    v_mov_b32 v194, 0
    v_mov_b32 v195, 0
    v_mov_b32 v196, 0
    v_mov_b32 v197, 0
    v_mov_b32 v198, 0
    v_mov_b32 v199, 0
    v_mov_b32 v200, 0
    v_mov_b32 v201, 0
    v_mov_b32 v202, 0
    v_mov_b32 v203, 0
    v_mov_b32 v204, 0
    v_mov_b32 v205, 0
    v_mov_b32 v206, 0
    v_mov_b32 v207, 0
    v_mov_b32 v208, 0
    v_mov_b32 v209, 0
    v_mov_b32 v210, 0
    v_mov_b32 v211, 0
    v_mov_b32 v212, 0
    v_mov_b32 v213, 0
    v_mov_b32 v214, 0
    v_mov_b32 v215, 0
    v_mov_b32 v216, 0
    v_mov_b32 v217, 0
    v_mov_b32 v218, 0
    v_mov_b32 v219, 0
    v_mov_b32 v220, 0
    v_mov_b32 v221, 0
    v_mov_b32 v222, 0
    v_mov_b32 v223, 0
    v_mov_b32 v224, 0
    v_mov_b32 v225, 0
    v_mov_b32 v226, 0
    v_mov_b32 v227, 0
    v_mov_b32 v228, 0
    v_mov_b32 v229, 0
    v_mov_b32 v230, 0
    v_mov_b32 v231, 0
    v_mov_b32 v232, 0
    v_mov_b32 v233, 0
    v_mov_b32 v234, 0
    v_mov_b32 v235, 0
    v_mov_b32 v236, 0
    v_mov_b32 v237, 0
    v_mov_b32 v238, 0
    v_mov_b32 v239, 0
    v_mov_b32 v240, 0
    v_mov_b32 v241, 0
    v_mov_b32 v242, 0
    v_mov_b32 v243, 0
    v_mov_b32 v244, 0
    v_mov_b32 v245, 0
    v_mov_b32 v246, 0
    v_mov_b32 v247, 0
    v_mov_b32 v248, 0
    v_mov_b32 v249, 0
    v_mov_b32 v250, 0
    v_mov_b32 v251, 0
    v_mov_b32 v252, 0
    v_mov_b32 v253, 0
    v_mov_b32 v254, 0
    v_mov_b32 v255, 0
    v_mov_b32 v104, 0
    v_mov_b32 v105, 0
    v_mov_b32 v106, 0
    v_mov_b32 v107, 0
    v_mov_b32 v108, 0
    v_mov_b32 v109, 0
    v_mov_b32 v110, 0
    v_mov_b32 v111, 0
    v_mov_b32 v112, 0
    v_mov_b32 v113, 0
    v_mov_b32 v114, 0
    v_mov_b32 v115, 0
    v_mov_b32 v116, 0
    v_mov_b32 v117, 0
    v_mov_b32 v118, 0
    v_mov_b32 v119, 0
    v_mov_b32 v120, 0
    v_mov_b32 v121, 0
    v_mov_b32 v122, 0
    v_mov_b32 v123, 0
    v_mov_b32 v124, 0
    v_mov_b32 v125, 0
    v_mov_b32 v126, 0
    v_mov_b32 v127, 0
    v_mov_b32 v128, 0
    v_mov_b32 v129, 0
    v_mov_b32 v130, 0
    v_mov_b32 v131, 0
    v_mov_b32 v132, 0
    v_mov_b32 v133, 0
    v_mov_b32 v134, 0
    v_mov_b32 v135, 0
    v_mov_b32 v160, 0
    v_mov_b32 v161, 0
    v_mov_b32 v162, 0
    v_mov_b32 v163, 0
    v_mov_b32 v164, 0
    v_mov_b32 v165, 0
    v_mov_b32 v166, 0
    v_mov_b32 v167, 0
    v_mov_b32 v168, 0
    v_mov_b32 v169, 0
    v_mov_b32 v170, 0
    v_mov_b32 v171, 0
    v_mov_b32 v172, 0
    v_mov_b32 v173, 0
    v_mov_b32 v174, 0
    v_mov_b32 v175, 0
    s_cmp_eq_u32 s30, 0
    s_cselect_b32 s45, 4, 2
    s_bitcmp1_b32 s30, 0
    s_cselect_b32 s53, 1.0, -1.0
    v_lshrrev_b32 v12, 3, v3
    v_and_b32 v13, 7, v3
    v_lshlrev_b32 v13, 4, v13
    v_lshl_add_u32 v12, v12, 2, v13
    v_add_u32 v12, s3, v12
    v_lshlrev_b32 v13, 5, v2
    v_add_u32 v13, s28, v13
    v_cvt_f32_u32 v13, v13
    v_add_u32 v14, 0, v12
    v_cvt_f32_u32 v14, v14
    v_mul_f32 v14, 0.00048828125, v14
    v_add_f32 v60, 0.0, v13
    v_mul_f32 v60, v60, v14
    v_add_f32 v61, 16.0, v13
    v_mul_f32 v61, v61, v14
    v_cos_f32 v62, v60
    v_cos_f32 v63, v61
    v_sin_f32 v64, v60
    v_sin_f32 v65, v61
    v_cvt_pk_bf16_f32 v136, v62, v63
    v_cvt_pk_bf16_f32 v144, v64, v65
    v_xor_b32 v152, 0x80008000, v144
    v_add_f32 v60, 128.0, v13
    v_mul_f32 v60, v60, v14
    v_add_f32 v61, 144.0, v13
    v_mul_f32 v61, v61, v14
    v_cos_f32 v62, v60
    v_cos_f32 v63, v61
    v_sin_f32 v64, v60
    v_sin_f32 v65, v61
    v_cvt_pk_bf16_f32 v137, v62, v63
    v_cvt_pk_bf16_f32 v145, v64, v65
    v_xor_b32 v153, 0x80008000, v145
    v_add_f32 v60, 256.0, v13
    v_mul_f32 v60, v60, v14
    v_add_f32 v61, 272.0, v13
    v_mul_f32 v61, v61, v14
    v_cos_f32 v62, v60
    v_cos_f32 v63, v61
    v_sin_f32 v64, v60
    v_sin_f32 v65, v61
    v_cvt_pk_bf16_f32 v138, v62, v63
    v_cvt_pk_bf16_f32 v146, v64, v65
    v_xor_b32 v154, 0x80008000, v146
    v_add_f32 v60, 384.0, v13
    v_mul_f32 v60, v60, v14
    v_add_f32 v61, 400.0, v13
    v_mul_f32 v61, v61, v14
    v_cos_f32 v62, v60
    v_cos_f32 v63, v61
    v_sin_f32 v64, v60
    v_sin_f32 v65, v61
    v_cvt_pk_bf16_f32 v139, v62, v63
    v_cvt_pk_bf16_f32 v147, v64, v65
    v_xor_b32 v155, 0x80008000, v147
    v_add_u32 v14, 8, v12
    v_cvt_f32_u32 v14, v14
    v_mul_f32 v14, 0.00048828125, v14
    v_add_f32 v60, 0.0, v13
    v_mul_f32 v60, v60, v14
    v_add_f32 v61, 16.0, v13
    v_mul_f32 v61, v61, v14
    v_cos_f32 v62, v60
    v_cos_f32 v63, v61
    v_sin_f32 v64, v60
    v_sin_f32 v65, v61
    v_cvt_pk_bf16_f32 v140, v62, v63
    v_cvt_pk_bf16_f32 v148, v64, v65
    v_xor_b32 v156, 0x80008000, v148
    v_add_f32 v60, 128.0, v13
    v_mul_f32 v60, v60, v14
    v_add_f32 v61, 144.0, v13
    v_mul_f32 v61, v61, v14
    v_cos_f32 v62, v60
    v_cos_f32 v63, v61
    v_sin_f32 v64, v60
    v_sin_f32 v65, v61
    v_cvt_pk_bf16_f32 v141, v62, v63
    v_cvt_pk_bf16_f32 v149, v64, v65
    v_xor_b32 v157, 0x80008000, v149
    v_add_f32 v60, 256.0, v13
    v_mul_f32 v60, v60, v14
    v_add_f32 v61, 272.0, v13
    v_mul_f32 v61, v61, v14
    v_cos_f32 v62, v60
    v_cos_f32 v63, v61
    v_sin_f32 v64, v60
    v_sin_f32 v65, v61
    v_cvt_pk_bf16_f32 v142, v62, v63
    v_cvt_pk_bf16_f32 v150, v64, v65
    v_xor_b32 v158, 0x80008000, v150
    v_add_f32 v60, 384.0, v13
    v_mul_f32 v60, v60, v14
    v_add_f32 v61, 400.0, v13
    v_mul_f32 v61, v61, v14
    v_cos_f32 v62, v60
    v_cos_f32 v63, v61
    v_sin_f32 v64, v60
    v_sin_f32 v65, v61
    v_cvt_pk_bf16_f32 v143, v62, v63
    v_cvt_pk_bf16_f32 v151, v64, v65
    v_xor_b32 v159, 0x80008000, v151
    s_cmp_ge_u32 s2, 240
    s_cbranch_scc1 L_wdf_14
    v_lshlrev_b32 v36, 6, v36
    v_lshl_add_u32 v36, v37, 3, v36
    v_add_u32 v36, s70, v36
    v_lshlrev_b32 v37, 4, v0
    s_lshl_b32 s77, s77, 3
    s_lshl_b32 s68, s3, 1
    s_add_u32 s77, s77, s68
    s_mul_i32 s76, s76, 5120
    s_add_u32 s76, s76, 6291456
    s_waitcnt vmcnt(0)
    ds_read_b64_tr_b16 v[48:49], v36 offset:0
    ds_read_b64_tr_b16 v[50:51], v36 offset:1024
    ds_read_b64_tr_b16 v[52:53], v36 offset:32
    ds_read_b64_tr_b16 v[54:55], v36 offset:1056
    s_add_u32 s68, s77, 0
    s_mul_hi_u32 s69, s68, 858993460
    s_mul_i32 s70, s69, 5
    s_sub_u32 s70, s68, s70
    s_mul_i32 s69, s69, 245760
    s_lshl_b32 s70, s70, 10
    s_add_u32 s69, s69, s70
    s_add_u32 s69, s69, s76
    s_waitcnt lgkmcnt(0)
    buffer_store_dwordx4 v[48:51], v37, s[12:15], s69 offen sc1
    s_add_u32 s68, s77, 1
    s_mul_hi_u32 s69, s68, 858993460
    s_mul_i32 s70, s69, 5
    s_sub_u32 s70, s68, s70
    s_mul_i32 s69, s69, 245760
    s_lshl_b32 s70, s70, 10
    s_add_u32 s69, s69, s70
    s_add_u32 s69, s69, s76
    s_waitcnt lgkmcnt(0)
    buffer_store_dwordx4 v[52:55], v37, s[12:15], s69 offen sc1
L_wdf_14:
    v_mov_b32 v5, 1
    v_mov_b32 v6, 149504
    v_mov_b32 v32, 0
    v_mov_b32 v33, 0
    v_mov_b32 v34, 0
    v_mov_b32 v35, 0
    s_barrier
    ds_read_b128 v[40:43], v8 offset:0
    ds_read_b128 v[44:47], v8 offset:2048
    ds_read_b128 v[48:51], v9 offset:0
    ds_read_b128 v[52:55], v9 offset:2048
    s_waitcnt lgkmcnt(0)
    v_lshlrev_b32 v36, 16, v40
    v_and_b32 v37, 0xffff0000, v40
    v_add_f32 v28, v36, v37
    v_lshlrev_b32 v36, 16, v41
    v_and_b32 v37, 0xffff0000, v41
    v_add_f32 v28, v28, v36
    v_add_f32 v28, v28, v37
    v_lshlrev_b32 v36, 16, v42
    v_and_b32 v37, 0xffff0000, v42
    v_add_f32 v28, v28, v36
    v_add_f32 v28, v28, v37
    v_lshlrev_b32 v36, 16, v43
    v_and_b32 v37, 0xffff0000, v43
    v_add_f32 v28, v28, v36
    v_add_f32 v28, v28, v37
    v_lshlrev_b32 v36, 16, v44
    v_and_b32 v37, 0xffff0000, v44
    v_add_f32 v29, v36, v37
    v_lshlrev_b32 v36, 16, v45
    v_and_b32 v37, 0xffff0000, v45
    v_add_f32 v29, v29, v36
    v_add_f32 v29, v29, v37
    v_lshlrev_b32 v36, 16, v46
    v_and_b32 v37, 0xffff0000, v46
    v_add_f32 v29, v29, v36
    v_add_f32 v29, v29, v37
    v_lshlrev_b32 v36, 16, v47
    v_and_b32 v37, 0xffff0000, v47
    v_add_f32 v29, v29, v36
    v_add_f32 v29, v29, v37
    v_mov_b32 v36, v28
    v_mov_b32 v37, v29
    s_nop 1
    v_permlane16_swap_b32 v28, v36
    v_permlane16_swap_b32 v29, v37
    s_nop 1
    v_add_f32 v28, v28, v36
    v_add_f32 v29, v29, v37
    v_mov_b32 v36, v28
    v_mov_b32 v37, v29
    s_nop 1
    v_permlane32_swap_b32 v28, v36
    v_permlane32_swap_b32 v29, v37
    s_nop 1
    v_add_f32 v28, v28, v36
    v_add_f32 v29, v29, v37
    s_bitcmp1_b32 s30, 0
    s_cselect_b32 s66, 0x3d000000, 0
    s_lshl_b32 s67, s3, 7
    s_add_u32 s67, s67, 150528
    v_lshlrev_b32 v38, 2, v3
    v_add_u32 v38, s67, v38
    v_mul_f32 v36, s66, v28
    v_mul_f32 v28, -2.0, v36
    v_mul_f32 v37, s66, v29
    v_mul_f32 v29, -2.0, v37
L_dloopA:
    v_mfma_f32_16x16x32_bf16 v[176:179], v[104:107], v[112:115], v[176:179]
    s_add_u32 s46, s46, 1
    s_cmp_eq_u32 s46, 3
    v_mfma_f32_16x16x32_bf16 v[196:199], v[108:111], v[112:115], v[196:199]
    s_cselect_b32 s42, s50, s51
    s_cselect_b32 s46, 0, s46
    v_mfma_f32_16x16x32_bf16 v[200:203], v[108:111], v[116:119], v[200:203]
    v_add_u32 v8, s42, v8
    v_add_u32 v9, s42, v9
    v_mfma_f32_16x16x32_bf16 v[180:183], v[104:107], v[116:119], v[180:183]
    v_add_u32 v10, s42, v10
    v_add_u32 v11, s42, v11
    v_mfma_f32_16x16x32_bf16 v[184:187], v[104:107], v[120:123], v[184:187]
    v_mfma_f32_16x16x32_bf16 v[204:207], v[108:111], v[120:123], v[204:207]
    s_waitcnt vmcnt(0) lgkmcnt(0)
    s_barrier
    v_mfma_f32_16x16x32_bf16 v[208:211], v[108:111], v[124:127], v[208:211]
    ds_read_b128 v[56:59], v8 offset:0
    ds_read_b128 v[60:63], v8 offset:2048
    ds_read_b128 v[64:67], v10 offset:0
    v_mfma_f32_16x16x32_bf16 v[188:191], v[104:107], v[124:127], v[188:191]
    ds_read_b128 v[68:71], v10 offset:2048
    ds_read_b128 v[72:75], v10 offset:4096
    ds_read_b128 v[76:79], v10 offset:6144
    v_mfma_f32_16x16x32_bf16 v[192:195], v[104:107], v[128:131], v[192:195]
    ds_read_b128 v[80:83], v10 offset:8192
    ds_read_b128 v[84:87], v10 offset:16384
    ds_read_b128 v[88:91], v10 offset:18432
    v_mfma_f32_16x16x32_bf16 v[212:215], v[108:111], v[128:131], v[212:215]
    ds_read_b128 v[92:95], v10 offset:20480
    ds_read_b128 v[96:99], v10 offset:22528
    ds_read_b128 v[100:103], v10 offset:24576
    s_add_u32 s47, s47, 1
    s_waitcnt lgkmcnt(10)
    v_mfma_f32_16x16x32_bf16 v[236:239], v[108:111], v[132:135], v[236:239]
    v_lshlrev_b32 v36, 16, v40
    v_and_b32 v37, 0xffff0000, v40
    v_lshlrev_b32 v38, 16, v56
    v_and_b32 v39, 0xffff0000, v56
    v_add_f32 v32, v32, v36
    v_mfma_f32_16x16x32_bf16 v[216:219], v[104:107], v[132:135], v[216:219]
    v_fmac_f32 v33, v36, v36
    v_add_f32 v32, v32, v37
    v_fmac_f32 v33, v37, v37
    v_add_f32 v32, v32, v38
    v_fmac_f32 v33, v38, v38
    v_mfma_f32_16x16x32_bf16 v[220:223], v[104:107], v[160:163], v[220:223]
    v_add_f32 v32, v32, v39
    v_fmac_f32 v33, v39, v39
    v_add_f32 v36, v28, v36
    v_add_f32 v37, v28, v37
    v_fmac_f32 v36, s53, v38
    v_mfma_f32_16x16x32_bf16 v[240:243], v[108:111], v[160:163], v[240:243]
    v_fmac_f32 v37, s53, v39
    v_cvt_pk_bf16_f32 v56, v36, v37
    v_lshlrev_b32 v36, 16, v41
    v_and_b32 v37, 0xffff0000, v41
    v_lshlrev_b32 v38, 16, v57
    v_mfma_f32_16x16x32_bf16 v[244:247], v[108:111], v[164:167], v[244:247]
    v_and_b32 v39, 0xffff0000, v57
    v_add_f32 v32, v32, v36
    v_fmac_f32 v33, v36, v36
    v_add_f32 v32, v32, v37
    v_fmac_f32 v33, v37, v37
    v_mfma_f32_16x16x32_bf16 v[224:227], v[104:107], v[164:167], v[224:227]
    v_add_f32 v32, v32, v38
    v_fmac_f32 v33, v38, v38
    v_add_f32 v32, v32, v39
    v_fmac_f32 v33, v39, v39
    v_add_f32 v36, v28, v36
    v_mfma_f32_16x16x32_bf16 v[228:231], v[104:107], v[168:171], v[228:231]
    v_add_f32 v37, v28, v37
    v_fmac_f32 v36, s53, v38
    v_fmac_f32 v37, s53, v39
    v_cvt_pk_bf16_f32 v57, v36, v37
    v_lshlrev_b32 v36, 16, v42
    v_mfma_f32_16x16x32_bf16 v[248:251], v[108:111], v[168:171], v[248:251]
    v_and_b32 v37, 0xffff0000, v42
    v_lshlrev_b32 v38, 16, v58
    v_and_b32 v39, 0xffff0000, v58
    v_add_f32 v32, v32, v36
    v_fmac_f32 v33, v36, v36
    v_mfma_f32_16x16x32_bf16 v[252:255], v[108:111], v[172:175], v[252:255]
    v_add_f32 v32, v32, v37
    v_fmac_f32 v33, v37, v37
    v_add_f32 v32, v32, v38
    v_fmac_f32 v33, v38, v38
    v_add_f32 v32, v32, v39
    v_mfma_f32_16x16x32_bf16 v[232:235], v[104:107], v[172:175], v[232:235]
    v_fmac_f32 v33, v39, v39
    v_add_f32 v36, v28, v36
    v_add_f32 v37, v28, v37
    v_fmac_f32 v36, s53, v38
    v_fmac_f32 v37, s53, v39
    v_cvt_pk_bf16_f32 v58, v36, v37
    v_lshlrev_b32 v36, 16, v43
    v_and_b32 v37, 0xffff0000, v43
    v_lshlrev_b32 v38, 16, v59
    v_and_b32 v39, 0xffff0000, v59
    v_add_f32 v32, v32, v36
    v_fmac_f32 v33, v36, v36
    v_add_f32 v32, v32, v37
    v_fmac_f32 v33, v37, v37
    v_add_f32 v32, v32, v38
    v_fmac_f32 v33, v38, v38
    v_add_f32 v32, v32, v39
    v_fmac_f32 v33, v39, v39
    v_add_f32 v36, v28, v36
    v_add_f32 v37, v28, v37
    v_fmac_f32 v36, s53, v38
    v_fmac_f32 v37, s53, v39
    v_cvt_pk_bf16_f32 v59, v36, v37
    v_lshlrev_b32 v36, 16, v44
    v_and_b32 v37, 0xffff0000, v44
    v_lshlrev_b32 v38, 16, v60
    v_and_b32 v39, 0xffff0000, v60
    v_add_f32 v34, v34, v36
    v_fmac_f32 v35, v36, v36
    v_add_f32 v34, v34, v37
    v_fmac_f32 v35, v37, v37
    v_add_f32 v34, v34, v38
    v_fmac_f32 v35, v38, v38
    v_add_f32 v34, v34, v39
    v_fmac_f32 v35, v39, v39
    v_add_f32 v36, v29, v36
    v_add_f32 v37, v29, v37
    v_fmac_f32 v36, s53, v38
    v_fmac_f32 v37, s53, v39
    v_cvt_pk_bf16_f32 v60, v36, v37
    v_lshlrev_b32 v36, 16, v45
    v_and_b32 v37, 0xffff0000, v45
    v_lshlrev_b32 v38, 16, v61
    v_and_b32 v39, 0xffff0000, v61
    v_add_f32 v34, v34, v36
    v_fmac_f32 v35, v36, v36
    v_add_f32 v34, v34, v37
    v_fmac_f32 v35, v37, v37
    v_add_f32 v34, v34, v38
    v_fmac_f32 v35, v38, v38
    v_add_f32 v34, v34, v39
    v_fmac_f32 v35, v39, v39
    v_add_f32 v36, v29, v36
    v_add_f32 v37, v29, v37
    v_fmac_f32 v36, s53, v38
    v_fmac_f32 v37, s53, v39
    v_cvt_pk_bf16_f32 v61, v36, v37
    v_lshlrev_b32 v36, 16, v46
    v_and_b32 v37, 0xffff0000, v46
    v_lshlrev_b32 v38, 16, v62
    v_and_b32 v39, 0xffff0000, v62
    v_add_f32 v34, v34, v36
    v_fmac_f32 v35, v36, v36
    v_add_f32 v34, v34, v37
    v_fmac_f32 v35, v37, v37
    v_add_f32 v34, v34, v38
    v_fmac_f32 v35, v38, v38
    v_add_f32 v34, v34, v39
    v_fmac_f32 v35, v39, v39
    v_add_f32 v36, v29, v36
    v_add_f32 v37, v29, v37
    v_fmac_f32 v36, s53, v38
    v_fmac_f32 v37, s53, v39
    v_cvt_pk_bf16_f32 v62, v36, v37
    v_lshlrev_b32 v36, 16, v47
    v_and_b32 v37, 0xffff0000, v47
    v_lshlrev_b32 v38, 16, v63
    v_and_b32 v39, 0xffff0000, v63
    v_add_f32 v34, v34, v36
    v_fmac_f32 v35, v36, v36
    v_add_f32 v34, v34, v37
    v_fmac_f32 v35, v37, v37
    v_add_f32 v34, v34, v38
    v_fmac_f32 v35, v38, v38
    v_add_f32 v34, v34, v39
    v_fmac_f32 v35, v39, v39
    v_add_f32 v36, v29, v36
    v_add_f32 v37, v29, v37
    v_fmac_f32 v36, s53, v38
    v_fmac_f32 v37, s53, v39
    v_cvt_pk_bf16_f32 v63, v36, v37
    s_waitcnt lgkmcnt(0)
    s_nop 0
    v_mfma_f32_16x16x32_bf16 v[176:179], v[56:59], v[64:67], v[176:179]
    ds_read_b128 v[104:107], v9 offset:0
    ds_read_b128 v[108:111], v9 offset:2048
    v_mfma_f32_16x16x32_bf16 v[196:199], v[60:63], v[64:67], v[196:199]
    ds_read_b128 v[112:115], v11 offset:0
    ds_read_b128 v[116:119], v11 offset:2048
    v_mfma_f32_16x16x32_bf16 v[200:203], v[60:63], v[68:71], v[200:203]
    ds_read_b128 v[120:123], v11 offset:4096
    ds_read_b128 v[124:127], v11 offset:6144
    v_mfma_f32_16x16x32_bf16 v[180:183], v[56:59], v[68:71], v[180:183]
    ds_read_b128 v[128:131], v11 offset:8192
    ds_read_b128 v[132:135], v11 offset:16384
    v_mfma_f32_16x16x32_bf16 v[184:187], v[56:59], v[72:75], v[184:187]
    ds_read_b128 v[160:163], v11 offset:18432
    ds_read_b128 v[164:167], v11 offset:20480
    v_mfma_f32_16x16x32_bf16 v[204:207], v[60:63], v[72:75], v[204:207]
    ds_read_b128 v[168:171], v11 offset:22528
    ds_read_b128 v[172:175], v11 offset:24576
    v_mfma_f32_16x16x32_bf16 v[208:211], v[60:63], v[76:79], v[208:211]
    s_waitcnt lgkmcnt(10)
    v_mfma_f32_16x16x32_bf16 v[188:191], v[56:59], v[76:79], v[188:191]
    v_lshlrev_b32 v36, 16, v48
    v_and_b32 v37, 0xffff0000, v48
    v_lshlrev_b32 v38, 16, v104
    v_and_b32 v39, 0xffff0000, v104
    v_add_f32 v32, v32, v36
    v_mfma_f32_16x16x32_bf16 v[192:195], v[56:59], v[80:83], v[192:195]
    v_fmac_f32 v33, v36, v36
    v_add_f32 v32, v32, v37
    v_fmac_f32 v33, v37, v37
    v_add_f32 v32, v32, v38
    v_fmac_f32 v33, v38, v38
    v_mfma_f32_16x16x32_bf16 v[212:215], v[60:63], v[80:83], v[212:215]
    v_add_f32 v32, v32, v39
    v_fmac_f32 v33, v39, v39
    v_add_f32 v36, v28, v36
    v_add_f32 v37, v28, v37
    v_fmac_f32 v36, s53, v38
    v_mfma_f32_16x16x32_bf16 v[236:239], v[60:63], v[84:87], v[236:239]
    v_fmac_f32 v37, s53, v39
    v_cvt_pk_bf16_f32 v104, v36, v37
    v_lshlrev_b32 v36, 16, v49
    v_and_b32 v37, 0xffff0000, v49
    v_lshlrev_b32 v38, 16, v105
    v_mfma_f32_16x16x32_bf16 v[216:219], v[56:59], v[84:87], v[216:219]
    v_and_b32 v39, 0xffff0000, v105
    v_add_f32 v32, v32, v36
    v_fmac_f32 v33, v36, v36
    v_add_f32 v32, v32, v37
    v_fmac_f32 v33, v37, v37
    v_mfma_f32_16x16x32_bf16 v[220:223], v[56:59], v[88:91], v[220:223]
    v_add_f32 v32, v32, v38
    v_fmac_f32 v33, v38, v38
    v_add_f32 v32, v32, v39
    v_fmac_f32 v33, v39, v39
    v_add_f32 v36, v28, v36
    v_mfma_f32_16x16x32_bf16 v[240:243], v[60:63], v[88:91], v[240:243]
    v_add_f32 v37, v28, v37
    v_fmac_f32 v36, s53, v38
    v_fmac_f32 v37, s53, v39
    v_cvt_pk_bf16_f32 v105, v36, v37
    v_lshlrev_b32 v36, 16, v50
    v_mfma_f32_16x16x32_bf16 v[244:247], v[60:63], v[92:95], v[244:247]
    v_and_b32 v37, 0xffff0000, v50
    v_lshlrev_b32 v38, 16, v106
    v_and_b32 v39, 0xffff0000, v106
    v_add_f32 v32, v32, v36
    v_fmac_f32 v33, v36, v36
    v_mfma_f32_16x16x32_bf16 v[224:227], v[56:59], v[92:95], v[224:227]
    v_add_f32 v32, v32, v37
    v_fmac_f32 v33, v37, v37
    v_add_f32 v32, v32, v38
    v_fmac_f32 v33, v38, v38
    v_add_f32 v32, v32, v39
    v_mfma_f32_16x16x32_bf16 v[228:231], v[56:59], v[96:99], v[228:231]
    v_fmac_f32 v33, v39, v39
    v_add_f32 v36, v28, v36
    v_add_f32 v37, v28, v37
    v_fmac_f32 v36, s53, v38
    v_fmac_f32 v37, s53, v39
    v_mfma_f32_16x16x32_bf16 v[248:251], v[60:63], v[96:99], v[248:251]
    v_cvt_pk_bf16_f32 v106, v36, v37
    v_lshlrev_b32 v36, 16, v51
    v_and_b32 v37, 0xffff0000, v51
    v_lshlrev_b32 v38, 16, v107
    v_and_b32 v39, 0xffff0000, v107
    v_mfma_f32_16x16x32_bf16 v[252:255], v[60:63], v[100:103], v[252:255]
    v_add_f32 v32, v32, v36
    v_fmac_f32 v33, v36, v36
    v_add_f32 v32, v32, v37
    v_fmac_f32 v33, v37, v37
    v_add_f32 v32, v32, v38
    v_mfma_f32_16x16x32_bf16 v[232:235], v[56:59], v[100:103], v[232:235]
    v_fmac_f32 v33, v38, v38
    v_add_f32 v32, v32, v39
    v_fmac_f32 v33, v39, v39
    v_add_f32 v36, v28, v36
    v_add_f32 v37, v28, v37
    v_fmac_f32 v36, s53, v38
    v_fmac_f32 v37, s53, v39
    v_cvt_pk_bf16_f32 v107, v36, v37
    v_lshlrev_b32 v36, 16, v52
    v_and_b32 v37, 0xffff0000, v52
    v_lshlrev_b32 v38, 16, v108
    v_and_b32 v39, 0xffff0000, v108
    v_add_f32 v34, v34, v36
    v_fmac_f32 v35, v36, v36
    v_add_f32 v34, v34, v37
    v_fmac_f32 v35, v37, v37
    v_add_f32 v34, v34, v38
    v_fmac_f32 v35, v38, v38
    v_add_f32 v34, v34, v39
    v_fmac_f32 v35, v39, v39
    v_add_f32 v36, v29, v36
    v_add_f32 v37, v29, v37
    v_fmac_f32 v36, s53, v38
    v_fmac_f32 v37, s53, v39
    v_cvt_pk_bf16_f32 v108, v36, v37
    v_lshlrev_b32 v36, 16, v53
    v_and_b32 v37, 0xffff0000, v53
    v_lshlrev_b32 v38, 16, v109
    v_and_b32 v39, 0xffff0000, v109
    v_add_f32 v34, v34, v36
    v_fmac_f32 v35, v36, v36
    v_add_f32 v34, v34, v37
    v_fmac_f32 v35, v37, v37
    v_add_f32 v34, v34, v38
    v_fmac_f32 v35, v38, v38
    v_add_f32 v34, v34, v39
    v_fmac_f32 v35, v39, v39
    v_add_f32 v36, v29, v36
    v_add_f32 v37, v29, v37
    v_fmac_f32 v36, s53, v38
    v_fmac_f32 v37, s53, v39
    v_cvt_pk_bf16_f32 v109, v36, v37
    v_lshlrev_b32 v36, 16, v54
    v_and_b32 v37, 0xffff0000, v54
    v_lshlrev_b32 v38, 16, v110
    v_and_b32 v39, 0xffff0000, v110
    v_add_f32 v34, v34, v36
    v_fmac_f32 v35, v36, v36
    v_add_f32 v34, v34, v37
    v_fmac_f32 v35, v37, v37
    v_add_f32 v34, v34, v38
    v_fmac_f32 v35, v38, v38
    v_add_f32 v34, v34, v39
    v_fmac_f32 v35, v39, v39
    v_add_f32 v36, v29, v36
    v_add_f32 v37, v29, v37
    v_fmac_f32 v36, s53, v38
    v_fmac_f32 v37, s53, v39
    v_cvt_pk_bf16_f32 v110, v36, v37
    v_lshlrev_b32 v36, 16, v55
    v_and_b32 v37, 0xffff0000, v55
    v_lshlrev_b32 v38, 16, v111
    v_and_b32 v39, 0xffff0000, v111
    v_add_f32 v34, v34, v36
    v_fmac_f32 v35, v36, v36
    v_add_f32 v34, v34, v37
    v_fmac_f32 v35, v37, v37
    v_add_f32 v34, v34, v38
    v_fmac_f32 v35, v38, v38
    v_add_f32 v34, v34, v39
    v_fmac_f32 v35, v39, v39
    v_add_f32 v36, v29, v36
    v_add_f32 v37, v29, v37
    v_fmac_f32 v36, s53, v38
    v_fmac_f32 v37, s53, v39
    v_cvt_pk_bf16_f32 v111, v36, v37
    s_add_u32 s46, s46, 1
    s_cmp_eq_u32 s46, 3
    s_cselect_b32 s42, s50, s51
    s_cselect_b32 s46, 0, s46
    v_add_u32 v8, s42, v8
    v_add_u32 v9, s42, v9
    v_add_u32 v10, s42, v10
    v_add_u32 v11, s42, v11
    s_waitcnt lgkmcnt(0)
    s_barrier
    s_add_u32 s47, s47, 1
    ds_read_b128 v[40:43], v8 offset:0
    ds_read_b128 v[44:47], v8 offset:2048
    ds_read_b128 v[48:51], v9 offset:0
    ds_read_b128 v[52:55], v9 offset:2048
    s_cmp_lt_u32 s47, s45
    s_cbranch_scc1 L_dloopA
    v_mov_b32 v36, 149536
    ds_read_b32 v14, v36
    v_mov_b32 v36, v32
    v_mov_b32 v37, v33
    v_mov_b32 v38, v34
    v_mov_b32 v39, v35
    s_nop 1
    v_permlane16_swap_b32 v32, v36
    v_permlane16_swap_b32 v33, v37
    v_permlane16_swap_b32 v34, v38
    v_permlane16_swap_b32 v35, v39
    s_nop 1
    v_add_f32 v32, v32, v36
    v_add_f32 v33, v33, v37
    v_add_f32 v34, v34, v38
    v_add_f32 v35, v35, v39
    v_mov_b32 v36, v32
    v_mov_b32 v37, v33
    v_mov_b32 v38, v34
    v_mov_b32 v39, v35
    s_nop 1
    v_permlane32_swap_b32 v32, v36
    v_permlane32_swap_b32 v33, v37
    v_permlane32_swap_b32 v34, v38
    v_permlane32_swap_b32 v35, v39
    s_nop 1
    v_add_f32 v32, v32, v36
    v_add_f32 v33, v33, v37
    v_add_f32 v34, v34, v38
    v_add_f32 v35, v35, v39
    s_lshl_b32 s66, s28, 2
    s_add_u32 s66, s66, s30
    s_lshl_b32 s66, s66, 11
    s_lshl_b32 s67, s3, 9
    s_add_u32 s66, s66, s67
    s_add_u32 s66, s66, 11534336
    v_cmp_gt_u32 vcc, 16, v0
    v_lshlrev_b32 v38, 4, v0
    s_waitcnt lgkmcnt(0)
    v_cndmask_b32 v12, v34, v32, vcc
    v_cndmask_b32 v13, v35, v33, vcc
    v_mov_b32 v15, v14
    v_readfirstlane_b32 s43, v14
    s_mov_b32 exec_hi, 0
    buffer_store_dwordx4 v[12:15], v38, s[12:15], s66 offen sc1
    s_mov_b64 exec, -1
    s_nop 0
L_dloopB:
    v_mfma_f32_16x16x32_bf16 v[176:179], v[104:107], v[112:115], v[176:179]
    s_add_u32 s46, s46, 1
    s_cmp_eq_u32 s46, 3
    v_mfma_f32_16x16x32_bf16 v[196:199], v[108:111], v[112:115], v[196:199]
    s_cselect_b32 s42, s50, s51
    s_cselect_b32 s46, 0, s46
    v_mfma_f32_16x16x32_bf16 v[200:203], v[108:111], v[116:119], v[200:203]
    v_add_u32 v8, s42, v8
    v_add_u32 v9, s42, v9
    v_mfma_f32_16x16x32_bf16 v[180:183], v[104:107], v[116:119], v[180:183]
    v_add_u32 v10, s42, v10
    v_add_u32 v11, s42, v11
    v_mfma_f32_16x16x32_bf16 v[184:187], v[104:107], v[120:123], v[184:187]
    v_mfma_f32_16x16x32_bf16 v[204:207], v[108:111], v[120:123], v[204:207]
    s_waitcnt lgkmcnt(0)
    s_cmp_ge_u32 s47, 8
    s_cbranch_scc1 L_ms_15_t
    s_barrier
L_ms_15_b:
    v_mfma_f32_16x16x32_bf16 v[208:211], v[108:111], v[124:127], v[208:211]
    ds_read_b128 v[56:59], v8 offset:0
    ds_read_b128 v[60:63], v8 offset:2048
    ds_read_b128 v[64:67], v10 offset:0
    v_mfma_f32_16x16x32_bf16 v[188:191], v[104:107], v[124:127], v[188:191]
    ds_read_b128 v[68:71], v10 offset:2048
    ds_read_b128 v[72:75], v10 offset:4096
    ds_read_b128 v[76:79], v10 offset:6144
    v_mfma_f32_16x16x32_bf16 v[192:195], v[104:107], v[128:131], v[192:195]
    ds_read_b128 v[80:83], v10 offset:8192
    ds_read_b128 v[84:87], v10 offset:16384
    ds_read_b128 v[88:91], v10 offset:18432
    v_mfma_f32_16x16x32_bf16 v[212:215], v[108:111], v[128:131], v[212:215]
    ds_read_b128 v[92:95], v10 offset:20480
    ds_read_b128 v[96:99], v10 offset:22528
    ds_read_b128 v[100:103], v10 offset:24576
    s_add_u32 s47, s47, 1
    s_waitcnt lgkmcnt(10)
    v_mfma_f32_16x16x32_bf16 v[236:239], v[108:111], v[132:135], v[236:239]
    v_lshlrev_b32 v36, 16, v40
    v_and_b32 v37, 0xffff0000, v40
    v_lshlrev_b32 v38, 16, v56
    v_and_b32 v39, 0xffff0000, v56
    v_add_f32 v36, v28, v36
    v_mfma_f32_16x16x32_bf16 v[216:219], v[104:107], v[132:135], v[216:219]
    v_add_f32 v37, v28, v37
    v_fmac_f32 v36, s53, v38
    v_fmac_f32 v37, s53, v39
    v_cvt_pk_bf16_f32 v56, v36, v37
    v_lshlrev_b32 v36, 16, v41
    v_mfma_f32_16x16x32_bf16 v[220:223], v[104:107], v[160:163], v[220:223]
    v_and_b32 v37, 0xffff0000, v41
    v_lshlrev_b32 v38, 16, v57
    v_and_b32 v39, 0xffff0000, v57
    v_add_f32 v36, v28, v36
    v_add_f32 v37, v28, v37
    v_mfma_f32_16x16x32_bf16 v[240:243], v[108:111], v[160:163], v[240:243]
    v_fmac_f32 v36, s53, v38
    v_fmac_f32 v37, s53, v39
    v_cvt_pk_bf16_f32 v57, v36, v37
    v_lshlrev_b32 v36, 16, v42
    v_and_b32 v37, 0xffff0000, v42
    v_mfma_f32_16x16x32_bf16 v[244:247], v[108:111], v[164:167], v[244:247]
    v_lshlrev_b32 v38, 16, v58
    v_and_b32 v39, 0xffff0000, v58
    v_add_f32 v36, v28, v36
    v_add_f32 v37, v28, v37
    v_fmac_f32 v36, s53, v38
    v_mfma_f32_16x16x32_bf16 v[224:227], v[104:107], v[164:167], v[224:227]
    v_fmac_f32 v37, s53, v39
    v_cvt_pk_bf16_f32 v58, v36, v37
    v_lshlrev_b32 v36, 16, v43
    v_and_b32 v37, 0xffff0000, v43
    v_lshlrev_b32 v38, 16, v59
    v_mfma_f32_16x16x32_bf16 v[228:231], v[104:107], v[168:171], v[228:231]
    v_and_b32 v39, 0xffff0000, v59
    v_add_f32 v36, v28, v36
    v_add_f32 v37, v28, v37
    v_fmac_f32 v36, s53, v38
    v_fmac_f32 v37, s53, v39
    v_mfma_f32_16x16x32_bf16 v[248:251], v[108:111], v[168:171], v[248:251]
    v_cvt_pk_bf16_f32 v59, v36, v37
    v_lshlrev_b32 v36, 16, v44
    v_and_b32 v37, 0xffff0000, v44
    v_lshlrev_b32 v38, 16, v60
    v_and_b32 v39, 0xffff0000, v60
    v_mfma_f32_16x16x32_bf16 v[252:255], v[108:111], v[172:175], v[252:255]
    v_add_f32 v36, v29, v36
    v_add_f32 v37, v29, v37
    v_fmac_f32 v36, s53, v38
    v_fmac_f32 v37, s53, v39
    v_cvt_pk_bf16_f32 v60, v36, v37
    v_mfma_f32_16x16x32_bf16 v[232:235], v[104:107], v[172:175], v[232:235]
    v_lshlrev_b32 v36, 16, v45
    v_and_b32 v37, 0xffff0000, v45
    v_lshlrev_b32 v38, 16, v61
    v_and_b32 v39, 0xffff0000, v61
    v_add_f32 v36, v29, v36
    v_add_f32 v37, v29, v37
    v_fmac_f32 v36, s53, v38
    v_fmac_f32 v37, s53, v39
    v_cvt_pk_bf16_f32 v61, v36, v37
    v_lshlrev_b32 v36, 16, v46
    v_and_b32 v37, 0xffff0000, v46
    v_lshlrev_b32 v38, 16, v62
    v_and_b32 v39, 0xffff0000, v62
    v_add_f32 v36, v29, v36
    v_add_f32 v37, v29, v37
    v_fmac_f32 v36, s53, v38
    v_fmac_f32 v37, s53, v39
    v_cvt_pk_bf16_f32 v62, v36, v37
    v_lshlrev_b32 v36, 16, v47
    v_and_b32 v37, 0xffff0000, v47
    v_lshlrev_b32 v38, 16, v63
    v_and_b32 v39, 0xffff0000, v63
    v_add_f32 v36, v29, v36
    v_add_f32 v37, v29, v37
    v_fmac_f32 v36, s53, v38
    v_fmac_f32 v37, s53, v39
    v_cvt_pk_bf16_f32 v63, v36, v37
    s_waitcnt lgkmcnt(0)
    s_nop 0
    v_mfma_f32_16x16x32_bf16 v[176:179], v[56:59], v[64:67], v[176:179]
    ds_read_b128 v[104:107], v9 offset:0
    ds_read_b128 v[108:111], v9 offset:2048
    v_mfma_f32_16x16x32_bf16 v[196:199], v[60:63], v[64:67], v[196:199]
    ds_read_b128 v[112:115], v11 offset:0
    ds_read_b128 v[116:119], v11 offset:2048
    v_mfma_f32_16x16x32_bf16 v[200:203], v[60:63], v[68:71], v[200:203]
    ds_read_b128 v[120:123], v11 offset:4096
    ds_read_b128 v[124:127], v11 offset:6144
    v_mfma_f32_16x16x32_bf16 v[180:183], v[56:59], v[68:71], v[180:183]
    ds_read_b128 v[128:131], v11 offset:8192
    ds_read_b128 v[132:135], v11 offset:16384
    v_mfma_f32_16x16x32_bf16 v[184:187], v[56:59], v[72:75], v[184:187]
    ds_read_b128 v[160:163], v11 offset:18432
    ds_read_b128 v[164:167], v11 offset:20480
    v_mfma_f32_16x16x32_bf16 v[204:207], v[60:63], v[72:75], v[204:207]
    ds_read_b128 v[168:171], v11 offset:22528
    ds_read_b128 v[172:175], v11 offset:24576
    v_mfma_f32_16x16x32_bf16 v[208:211], v[60:63], v[76:79], v[208:211]
    ds_read2_b32 v[14:15], v6 offset0:3 offset1:6
    s_waitcnt lgkmcnt(11)
    v_mfma_f32_16x16x32_bf16 v[188:191], v[56:59], v[76:79], v[188:191]
    v_lshlrev_b32 v36, 16, v48
    v_and_b32 v37, 0xffff0000, v48
    v_lshlrev_b32 v38, 16, v104
    v_and_b32 v39, 0xffff0000, v104
    v_add_f32 v36, v28, v36
    v_mfma_f32_16x16x32_bf16 v[192:195], v[56:59], v[80:83], v[192:195]
    v_add_f32 v37, v28, v37
    v_fmac_f32 v36, s53, v38
    v_fmac_f32 v37, s53, v39
    v_cvt_pk_bf16_f32 v104, v36, v37
    v_lshlrev_b32 v36, 16, v49
    v_mfma_f32_16x16x32_bf16 v[212:215], v[60:63], v[80:83], v[212:215]
    v_and_b32 v37, 0xffff0000, v49
    v_lshlrev_b32 v38, 16, v105
    v_and_b32 v39, 0xffff0000, v105
    v_add_f32 v36, v28, v36
    v_add_f32 v37, v28, v37
    v_mfma_f32_16x16x32_bf16 v[236:239], v[60:63], v[84:87], v[236:239]
    v_fmac_f32 v36, s53, v38
    v_fmac_f32 v37, s53, v39
    v_cvt_pk_bf16_f32 v105, v36, v37
    v_lshlrev_b32 v36, 16, v50
    v_and_b32 v37, 0xffff0000, v50
    v_mfma_f32_16x16x32_bf16 v[216:219], v[56:59], v[84:87], v[216:219]
    v_lshlrev_b32 v38, 16, v106
    v_and_b32 v39, 0xffff0000, v106
    v_add_f32 v36, v28, v36
    v_add_f32 v37, v28, v37
    v_fmac_f32 v36, s53, v38
    v_mfma_f32_16x16x32_bf16 v[220:223], v[56:59], v[88:91], v[220:223]
    v_fmac_f32 v37, s53, v39
    v_cvt_pk_bf16_f32 v106, v36, v37
    v_lshlrev_b32 v36, 16, v51
    v_and_b32 v37, 0xffff0000, v51
    v_lshlrev_b32 v38, 16, v107
    v_mfma_f32_16x16x32_bf16 v[240:243], v[60:63], v[88:91], v[240:243]
    v_and_b32 v39, 0xffff0000, v107
    v_add_f32 v36, v28, v36
    v_add_f32 v37, v28, v37
    v_fmac_f32 v36, s53, v38
    v_fmac_f32 v37, s53, v39
    v_mfma_f32_16x16x32_bf16 v[244:247], v[60:63], v[92:95], v[244:247]
    v_cvt_pk_bf16_f32 v107, v36, v37
    v_lshlrev_b32 v36, 16, v52
    v_and_b32 v37, 0xffff0000, v52
    v_lshlrev_b32 v38, 16, v108
    v_and_b32 v39, 0xffff0000, v108
    v_mfma_f32_16x16x32_bf16 v[224:227], v[56:59], v[92:95], v[224:227]
    v_add_f32 v36, v29, v36
    v_add_f32 v37, v29, v37
    v_fmac_f32 v36, s53, v38
    v_fmac_f32 v37, s53, v39
    v_cvt_pk_bf16_f32 v108, v36, v37
    v_mfma_f32_16x16x32_bf16 v[228:231], v[56:59], v[96:99], v[228:231]
    v_lshlrev_b32 v36, 16, v53
    v_and_b32 v37, 0xffff0000, v53
    v_lshlrev_b32 v38, 16, v109
    v_and_b32 v39, 0xffff0000, v109
    v_add_f32 v36, v29, v36
    v_mfma_f32_16x16x32_bf16 v[248:251], v[60:63], v[96:99], v[248:251]
    v_add_f32 v37, v29, v37
    v_fmac_f32 v36, s53, v38
    v_fmac_f32 v37, s53, v39
    v_cvt_pk_bf16_f32 v109, v36, v37
    v_lshlrev_b32 v36, 16, v54
    v_mfma_f32_16x16x32_bf16 v[252:255], v[60:63], v[100:103], v[252:255]
    v_and_b32 v37, 0xffff0000, v54
    v_lshlrev_b32 v38, 16, v110
    v_and_b32 v39, 0xffff0000, v110
    v_add_f32 v36, v29, v36
    v_add_f32 v37, v29, v37
    v_mfma_f32_16x16x32_bf16 v[232:235], v[56:59], v[100:103], v[232:235]
    v_fmac_f32 v36, s53, v38
    v_fmac_f32 v37, s53, v39
    v_cvt_pk_bf16_f32 v110, v36, v37
    v_lshlrev_b32 v36, 16, v55
    v_and_b32 v37, 0xffff0000, v55
    v_lshlrev_b32 v38, 16, v111
    v_and_b32 v39, 0xffff0000, v111
    v_add_f32 v36, v29, v36
    v_add_f32 v37, v29, v37
    v_fmac_f32 v36, s53, v38
    v_fmac_f32 v37, s53, v39
    v_cvt_pk_bf16_f32 v111, v36, v37
    s_add_u32 s46, s46, 1
    s_cmp_eq_u32 s46, 3
    s_cselect_b32 s42, s50, s51
    s_cselect_b32 s46, 0, s46
    v_add_u32 v8, s42, v8
    v_add_u32 v9, s42, v9
    v_add_u32 v10, s42, v10
    v_add_u32 v11, s42, v11
    s_waitcnt lgkmcnt(0)
    s_cmp_ge_u32 s47, 8
    s_cbranch_scc1 L_ms_16_t
    s_barrier
L_ms_16_b:
    s_add_u32 s47, s47, 1
    ds_read_b128 v[40:43], v8 offset:0
    ds_read_b128 v[44:47], v8 offset:2048
    ds_read_b128 v[48:51], v9 offset:0
    ds_read_b128 v[52:55], v9 offset:2048
    ds_read2_b32 v[14:15], v6 offset0:3 offset1:6
    s_branch L_dloopB
L_ms_15_t:
    s_mov_b64 exec, 1
    s_cmp_eq_u32 s47, 9
    s_cbranch_scc1 L_ms_15_9
    ds_add_u32 v6, v5 offset:16
    s_mov_b64 exec, -1
    v_readfirstlane_b32 s78, v14
    s_cmp_ge_u32 s78, 3
    s_cbranch_scc1 L_ms_15_b
    v_mov_b32 v14, 149504
    s_mov_b32 s100, 0
L_ms_15_w:
    ds_read_b32 v15, v14 offset:12
    s_waitcnt lgkmcnt(0)
    v_readfirstlane_b32 s78, v15
    s_cmp_lt_u32 s78, 3
    s_cbranch_scc0 L_ms_15_w_ok
    s_add_u32 s100, s100, 1
    s_cmp_lt_u32 s100, 8388608
    s_sleep 3
    s_cbranch_scc1 L_ms_15_w
L_ms_15_w_ok:
    s_branch L_ms_15_b
L_ms_15_9:
    ds_add_u32 v6, v5 offset:20
    s_mov_b64 exec, -1
    s_branch L_dlast
L_ms_16_t:
    s_mov_b64 exec, 1
    s_cmp_eq_u32 s47, 9
    s_cbranch_scc1 L_ms_16_9
    ds_add_u32 v6, v5 offset:16
    s_mov_b64 exec, -1
    v_readfirstlane_b32 s78, v14
    s_cmp_ge_u32 s78, 3
    s_cbranch_scc1 L_ms_16_b
    v_mov_b32 v14, 149504
    s_mov_b32 s100, 0
L_ms_16_w:
    ds_read_b32 v15, v14 offset:12
    s_waitcnt lgkmcnt(0)
    v_readfirstlane_b32 s78, v15
    s_cmp_lt_u32 s78, 3
    s_cbranch_scc0 L_ms_16_w_ok
    s_add_u32 s100, s100, 1
    s_cmp_lt_u32 s100, 8388608
    s_sleep 3
    s_cbranch_scc1 L_ms_16_w
L_ms_16_w_ok:
    s_branch L_ms_16_b
L_ms_16_9:
    ds_add_u32 v6, v5 offset:20
    s_mov_b64 exec, -1
    s_branch L_dlast
L_dlast:
    buffer_load_dwordx4 v[32:35], v17, s[4:7], 0 offen
    buffer_load_dwordx4 v[36:39], v20, s[4:7], 0 offen
    buffer_load_dwordx4 v[28:31], v23, s[4:7], 0 offen
    v_readfirstlane_b32 s78, v15
    s_cmp_ge_u32 s78, 1
    s_cbranch_scc1 L_dst_ok
    v_mov_b32 v14, 149504
    s_mov_b32 s100, 0
L_dst:
    ds_read_b32 v15, v14 offset:24
    s_waitcnt lgkmcnt(0)
    v_readfirstlane_b32 s78, v15
    s_cmp_lt_u32 s78, 1
    s_cbranch_scc0 L_dst_ok
    s_add_u32 s100, s100, 1
    s_cmp_lt_u32 s100, 8388608
    s_sleep 3
    s_cbranch_scc1 L_dst
L_dst_ok:
    v_mfma_f32_16x16x32_bf16 v[176:179], v[104:107], v[112:115], v[176:179]
    s_lshl_b32 s66, s3, 7
    s_add_u32 s66, s66, 147456
    v_mfma_f32_16x16x32_bf16 v[196:199], v[108:111], v[112:115], v[196:199]
    v_lshlrev_b32 v4, 4, v2
    v_add_u32 v4, s66, v4
    v_mfma_f32_16x16x32_bf16 v[200:203], v[108:111], v[116:119], v[200:203]
    ds_read_b128 v[40:43], v4 offset:0
    ds_read_b128 v[76:79], v4 offset:2560
    v_mfma_f32_16x16x32_bf16 v[180:183], v[104:107], v[116:119], v[180:183]
    ds_read_b128 v[44:47], v4 offset:64
    ds_read_b128 v[80:83], v4 offset:2624
    v_mfma_f32_16x16x32_bf16 v[184:187], v[104:107], v[120:123], v[184:187]
    v_lshlrev_b32 v5, 2, v3
    v_add_u32 v5, 148480, v5
    v_mfma_f32_16x16x32_bf16 v[204:207], v[108:111], v[120:123], v[204:207]
    v_bfe_u32 v9, v3, 1, 2
    v_xor_b32 v8, s3, v9
    v_mfma_f32_16x16x32_bf16 v[208:211], v[108:111], v[124:127], v[208:211]
    v_lshlrev_b32 v8, 4, v8
    v_lshl_add_u32 v8, v3, 6, v8
    v_mfma_f32_16x16x32_bf16 v[188:191], v[104:107], v[124:127], v[188:191]
    v_lshl_add_u32 v8, v2, 2, v8
    ds_read_b32 v14, v6 offset:20
    v_mfma_f32_16x16x32_bf16 v[192:195], v[104:107], v[128:131], v[192:195]
    v_mfma_f32_16x16x32_bf16 v[212:215], v[108:111], v[128:131], v[212:215]
    v_mfma_f32_16x16x32_bf16 v[236:239], v[108:111], v[132:135], v[236:239]
    v_mfma_f32_16x16x32_bf16 v[216:219], v[104:107], v[132:135], v[216:219]
    v_mfma_f32_16x16x32_bf16 v[220:223], v[104:107], v[160:163], v[220:223]
    v_mfma_f32_16x16x32_bf16 v[240:243], v[108:111], v[160:163], v[240:243]
    v_mfma_f32_16x16x32_bf16 v[244:247], v[108:111], v[164:167], v[244:247]
    v_mfma_f32_16x16x32_bf16 v[224:227], v[104:107], v[164:167], v[224:227]
    v_mfma_f32_16x16x32_bf16 v[228:231], v[104:107], v[168:171], v[228:231]
    v_mfma_f32_16x16x32_bf16 v[248:251], v[108:111], v[168:171], v[248:251]
    v_mfma_f32_16x16x32_bf16 v[252:255], v[108:111], v[172:175], v[252:255]
    v_mfma_f32_16x16x32_bf16 v[232:235], v[104:107], v[172:175], v[232:235]
    s_waitcnt lgkmcnt(0)
    v_readfirstlane_b32 s78, v14
    s_cmp_ge_u32 s78, 4
    s_cbranch_scc1 L_dc9_ok
    v_mov_b32 v14, 149504
    s_mov_b32 s100, 0
L_dc9:
    ds_read_b32 v15, v14 offset:20
    s_waitcnt lgkmcnt(0)
    v_readfirstlane_b32 s78, v15
    s_cmp_lt_u32 s78, 4
    s_cbranch_scc0 L_dc9_ok
    s_add_u32 s100, s100, 1
    s_cmp_lt_u32 s100, 8388608
    s_sleep 3
    s_cbranch_scc1 L_dc9
L_dc9_ok:
    s_cmp_lg_u32 s30, 0
    s_cbranch_scc1 L_z0
    v_pk_add_f32 v[84:85], v[76:77], v[78:79]
    v_pk_add_f32 v[86:87], v[76:77], v[78:79] neg_lo:[0,1] neg_hi:[0,1]
    v_add_f32 v92, v84, v85
    v_sub_f32 v94, v84, v85
    v_pk_add_f32 v[88:89], v[80:81], v[82:83]
    v_pk_add_f32 v[90:91], v[80:81], v[82:83] neg_lo:[0,1] neg_hi:[0,1]
    v_add_f32 v93, v88, v89
    v_sub_f32 v95, v88, v89
    v_cvt_pk_bf16_f32 v96, v92, v93
    v_mov_b32 v97, 0
    v_cvt_pk_bf16_f32 v98, v86, v90
    v_cvt_pk_bf16_f32 v101, v87, v91
    v_xor_b32 v99, 0x80008000, v101
    v_cvt_pk_bf16_f32 v100, v94, v95
    ds_write_b32 v8, v96 offset:5120
    ds_write_b32 v8, v97 offset:11264
    ds_write_b32 v8, v98 offset:17408
    ds_write_b32 v8, v99 offset:23552
    ds_write_b32 v8, v100 offset:29696
    ds_write_b32 v8, v97 offset:35840
    ds_write_b32 v8, v98 offset:41984
    ds_write_b32 v8, v101 offset:48128
L_z0:
    v_pk_mul_f32 v[176:177], v[176:177], v[40:41]
    v_pk_mul_f32 v[178:179], v[178:179], v[42:43]
    v_pk_mul_f32 v[216:217], v[216:217], v[40:41]
    v_pk_mul_f32 v[218:219], v[218:219], v[42:43]
    v_pk_add_f32 v[80:81], v[176:177], v[178:179]
    v_pk_add_f32 v[82:83], v[176:177], v[178:179] neg_lo:[0,1] neg_hi:[0,1]
    v_pk_add_f32 v[84:85], v[216:217], v[218:219]
    v_pk_add_f32 v[86:87], v[216:217], v[218:219] neg_lo:[0,1] neg_hi:[0,1]
    v_add_f32 v88, v80, v81
    v_add_f32 v89, v84, v85
    v_add_f32 v90, v82, v87
    v_sub_f32 v91, v86, v83
    v_sub_f32 v92, v80, v81
    v_sub_f32 v93, v84, v85
    v_sub_f32 v94, v82, v87
    v_add_f32 v95, v86, v83
    v_pk_mul_f32 v[196:197], v[196:197], v[44:45]
    v_pk_mul_f32 v[198:199], v[198:199], v[46:47]
    v_pk_mul_f32 v[236:237], v[236:237], v[44:45]
    v_pk_mul_f32 v[238:239], v[238:239], v[46:47]
    v_pk_add_f32 v[96:97], v[196:197], v[198:199]
    v_pk_add_f32 v[98:99], v[196:197], v[198:199] neg_lo:[0,1] neg_hi:[0,1]
    v_pk_add_f32 v[100:101], v[236:237], v[238:239]
    v_pk_add_f32 v[102:103], v[236:237], v[238:239] neg_lo:[0,1] neg_hi:[0,1]
    v_add_f32 v104, v96, v97
    v_add_f32 v105, v100, v101
    v_add_f32 v106, v98, v103
    v_sub_f32 v107, v102, v99
    v_sub_f32 v108, v96, v97
    v_sub_f32 v109, v100, v101
    v_sub_f32 v110, v98, v103
    v_add_f32 v111, v102, v99
    v_cvt_pk_bf16_f32 v112, v88, v104
    v_cvt_pk_bf16_f32 v113, v89, v105
    v_cvt_pk_bf16_f32 v114, v90, v106
    v_cvt_pk_bf16_f32 v115, v91, v107
    v_cvt_pk_bf16_f32 v116, v92, v108
    v_cvt_pk_bf16_f32 v117, v93, v109
    v_cvt_pk_bf16_f32 v118, v94, v110
    v_cvt_pk_bf16_f32 v119, v95, v111
    ds_write_b32 v8, v112 offset:0
    ds_write_b32 v8, v113 offset:6144
    ds_write_b32 v8, v114 offset:12288
    ds_write_b32 v8, v115 offset:18432
    ds_write_b32 v8, v116 offset:24576
    ds_write_b32 v8, v117 offset:30720
    ds_write_b32 v8, v118 offset:36864
    ds_write_b32 v8, v119 offset:43008
    v_pk_mul_f32 v[180:181], v[180:181], v[40:41]
    v_pk_mul_f32 v[182:183], v[182:183], v[42:43]
    v_pk_mul_f32 v[220:221], v[220:221], v[40:41]
    v_pk_mul_f32 v[222:223], v[222:223], v[42:43]
    v_pk_add_f32 v[80:81], v[180:181], v[182:183]
    v_pk_add_f32 v[82:83], v[180:181], v[182:183] neg_lo:[0,1] neg_hi:[0,1]
    v_pk_add_f32 v[84:85], v[220:221], v[222:223]
    v_pk_add_f32 v[86:87], v[220:221], v[222:223] neg_lo:[0,1] neg_hi:[0,1]
    v_add_f32 v88, v80, v81
    v_add_f32 v89, v84, v85
    v_add_f32 v90, v82, v87
    v_sub_f32 v91, v86, v83
    v_sub_f32 v92, v80, v81
    v_sub_f32 v93, v84, v85
    v_sub_f32 v94, v82, v87
    v_add_f32 v95, v86, v83
    v_pk_mul_f32 v[200:201], v[200:201], v[44:45]
    v_pk_mul_f32 v[202:203], v[202:203], v[46:47]
    v_pk_mul_f32 v[240:241], v[240:241], v[44:45]
    v_pk_mul_f32 v[242:243], v[242:243], v[46:47]
    v_pk_add_f32 v[96:97], v[200:201], v[202:203]
    v_pk_add_f32 v[98:99], v[200:201], v[202:203] neg_lo:[0,1] neg_hi:[0,1]
    v_pk_add_f32 v[100:101], v[240:241], v[242:243]
    v_pk_add_f32 v[102:103], v[240:241], v[242:243] neg_lo:[0,1] neg_hi:[0,1]
    v_add_f32 v104, v96, v97
    v_add_f32 v105, v100, v101
    v_add_f32 v106, v98, v103
    v_sub_f32 v107, v102, v99
    v_sub_f32 v108, v96, v97
    v_sub_f32 v109, v100, v101
    v_sub_f32 v110, v98, v103
    v_add_f32 v111, v102, v99
    v_cvt_pk_bf16_f32 v112, v88, v104
    v_cvt_pk_bf16_f32 v113, v89, v105
    v_cvt_pk_bf16_f32 v114, v90, v106
    v_cvt_pk_bf16_f32 v115, v91, v107
    v_cvt_pk_bf16_f32 v116, v92, v108
    v_cvt_pk_bf16_f32 v117, v93, v109
    v_cvt_pk_bf16_f32 v118, v94, v110
    v_cvt_pk_bf16_f32 v119, v95, v111
    ds_write_b32 v8, v112 offset:1024
    ds_write_b32 v8, v113 offset:7168
    ds_write_b32 v8, v114 offset:13312
    ds_write_b32 v8, v115 offset:19456
    ds_write_b32 v8, v116 offset:25600
    ds_write_b32 v8, v117 offset:31744
    ds_write_b32 v8, v118 offset:37888
    ds_write_b32 v8, v119 offset:44032
    v_pk_mul_f32 v[184:185], v[184:185], v[40:41]
    v_pk_mul_f32 v[186:187], v[186:187], v[42:43]
    v_pk_mul_f32 v[224:225], v[224:225], v[40:41]
    v_pk_mul_f32 v[226:227], v[226:227], v[42:43]
    v_pk_add_f32 v[80:81], v[184:185], v[186:187]
    v_pk_add_f32 v[82:83], v[184:185], v[186:187] neg_lo:[0,1] neg_hi:[0,1]
    v_pk_add_f32 v[84:85], v[224:225], v[226:227]
    v_pk_add_f32 v[86:87], v[224:225], v[226:227] neg_lo:[0,1] neg_hi:[0,1]
    v_add_f32 v88, v80, v81
    v_add_f32 v89, v84, v85
    v_add_f32 v90, v82, v87
    v_sub_f32 v91, v86, v83
    v_sub_f32 v92, v80, v81
    v_sub_f32 v93, v84, v85
    v_sub_f32 v94, v82, v87
    v_add_f32 v95, v86, v83
    v_pk_mul_f32 v[204:205], v[204:205], v[44:45]
    v_pk_mul_f32 v[206:207], v[206:207], v[46:47]
    v_pk_mul_f32 v[244:245], v[244:245], v[44:45]
    v_pk_mul_f32 v[246:247], v[246:247], v[46:47]
    v_pk_add_f32 v[96:97], v[204:205], v[206:207]
    v_pk_add_f32 v[98:99], v[204:205], v[206:207] neg_lo:[0,1] neg_hi:[0,1]
    v_pk_add_f32 v[100:101], v[244:245], v[246:247]
    v_pk_add_f32 v[102:103], v[244:245], v[246:247] neg_lo:[0,1] neg_hi:[0,1]
    v_add_f32 v104, v96, v97
    v_add_f32 v105, v100, v101
    v_add_f32 v106, v98, v103
    v_sub_f32 v107, v102, v99
    v_sub_f32 v108, v96, v97
    v_sub_f32 v109, v100, v101
    v_sub_f32 v110, v98, v103
    v_add_f32 v111, v102, v99
    v_cvt_pk_bf16_f32 v112, v88, v104
    v_cvt_pk_bf16_f32 v113, v89, v105
    v_cvt_pk_bf16_f32 v114, v90, v106
    v_cvt_pk_bf16_f32 v115, v91, v107
    v_cvt_pk_bf16_f32 v116, v92, v108
    v_cvt_pk_bf16_f32 v117, v93, v109
    v_cvt_pk_bf16_f32 v118, v94, v110
    v_cvt_pk_bf16_f32 v119, v95, v111
    ds_write_b32 v8, v112 offset:2048
    ds_write_b32 v8, v113 offset:8192
    ds_write_b32 v8, v114 offset:14336
    ds_write_b32 v8, v115 offset:20480
    ds_write_b32 v8, v116 offset:26624
    ds_write_b32 v8, v117 offset:32768
    ds_write_b32 v8, v118 offset:38912
    ds_write_b32 v8, v119 offset:45056
    v_pk_mul_f32 v[188:189], v[188:189], v[40:41]
    v_pk_mul_f32 v[190:191], v[190:191], v[42:43]
    v_pk_mul_f32 v[228:229], v[228:229], v[40:41]
    v_pk_mul_f32 v[230:231], v[230:231], v[42:43]
    v_pk_add_f32 v[80:81], v[188:189], v[190:191]
    v_pk_add_f32 v[82:83], v[188:189], v[190:191] neg_lo:[0,1] neg_hi:[0,1]
    v_pk_add_f32 v[84:85], v[228:229], v[230:231]
    v_pk_add_f32 v[86:87], v[228:229], v[230:231] neg_lo:[0,1] neg_hi:[0,1]
    v_add_f32 v88, v80, v81
    v_add_f32 v89, v84, v85
    v_add_f32 v90, v82, v87
    v_sub_f32 v91, v86, v83
    v_sub_f32 v92, v80, v81
    v_sub_f32 v93, v84, v85
    v_sub_f32 v94, v82, v87
    v_add_f32 v95, v86, v83
    v_pk_mul_f32 v[208:209], v[208:209], v[44:45]
    v_pk_mul_f32 v[210:211], v[210:211], v[46:47]
    v_pk_mul_f32 v[248:249], v[248:249], v[44:45]
    v_pk_mul_f32 v[250:251], v[250:251], v[46:47]
    v_pk_add_f32 v[96:97], v[208:209], v[210:211]
    v_pk_add_f32 v[98:99], v[208:209], v[210:211] neg_lo:[0,1] neg_hi:[0,1]
    v_pk_add_f32 v[100:101], v[248:249], v[250:251]
    v_pk_add_f32 v[102:103], v[248:249], v[250:251] neg_lo:[0,1] neg_hi:[0,1]
    v_add_f32 v104, v96, v97
    v_add_f32 v105, v100, v101
    v_add_f32 v106, v98, v103
    v_sub_f32 v107, v102, v99
    v_sub_f32 v108, v96, v97
    v_sub_f32 v109, v100, v101
    v_sub_f32 v110, v98, v103
    v_add_f32 v111, v102, v99
    v_cvt_pk_bf16_f32 v112, v88, v104
    v_cvt_pk_bf16_f32 v113, v89, v105
    v_cvt_pk_bf16_f32 v114, v90, v106
    v_cvt_pk_bf16_f32 v115, v91, v107
    v_cvt_pk_bf16_f32 v116, v92, v108
    v_cvt_pk_bf16_f32 v117, v93, v109
    v_cvt_pk_bf16_f32 v118, v94, v110
    v_cvt_pk_bf16_f32 v119, v95, v111
    ds_write_b32 v8, v112 offset:3072
    ds_write_b32 v8, v113 offset:9216
    ds_write_b32 v8, v114 offset:15360
    ds_write_b32 v8, v115 offset:21504
    ds_write_b32 v8, v116 offset:27648
    ds_write_b32 v8, v117 offset:33792
    ds_write_b32 v8, v118 offset:39936
    ds_write_b32 v8, v119 offset:46080
    v_pk_mul_f32 v[192:193], v[192:193], v[40:41]
    v_pk_mul_f32 v[194:195], v[194:195], v[42:43]
    v_pk_mul_f32 v[232:233], v[232:233], v[40:41]
    v_pk_mul_f32 v[234:235], v[234:235], v[42:43]
    v_pk_add_f32 v[80:81], v[192:193], v[194:195]
    v_pk_add_f32 v[82:83], v[192:193], v[194:195] neg_lo:[0,1] neg_hi:[0,1]
    v_pk_add_f32 v[84:85], v[232:233], v[234:235]
    v_pk_add_f32 v[86:87], v[232:233], v[234:235] neg_lo:[0,1] neg_hi:[0,1]
    v_add_f32 v88, v80, v81
    v_add_f32 v89, v84, v85
    v_add_f32 v90, v82, v87
    v_sub_f32 v91, v86, v83
    v_sub_f32 v92, v80, v81
    v_sub_f32 v93, v84, v85
    v_sub_f32 v94, v82, v87
    v_add_f32 v95, v86, v83
    v_pk_mul_f32 v[212:213], v[212:213], v[44:45]
    v_pk_mul_f32 v[214:215], v[214:215], v[46:47]
    v_pk_mul_f32 v[252:253], v[252:253], v[44:45]
    v_pk_mul_f32 v[254:255], v[254:255], v[46:47]
    v_pk_add_f32 v[96:97], v[212:213], v[214:215]
    v_pk_add_f32 v[98:99], v[212:213], v[214:215] neg_lo:[0,1] neg_hi:[0,1]
    v_pk_add_f32 v[100:101], v[252:253], v[254:255]
    v_pk_add_f32 v[102:103], v[252:253], v[254:255] neg_lo:[0,1] neg_hi:[0,1]
    v_add_f32 v104, v96, v97
    v_add_f32 v105, v100, v101
    v_add_f32 v106, v98, v103
    v_sub_f32 v107, v102, v99
    v_sub_f32 v108, v96, v97
    v_sub_f32 v109, v100, v101
    v_sub_f32 v110, v98, v103
    v_add_f32 v111, v102, v99
    v_cvt_pk_bf16_f32 v112, v88, v104
    v_cvt_pk_bf16_f32 v113, v89, v105
    v_cvt_pk_bf16_f32 v114, v90, v106
    v_cvt_pk_bf16_f32 v115, v91, v107
    v_cvt_pk_bf16_f32 v116, v92, v108
    v_cvt_pk_bf16_f32 v117, v93, v109
    v_cvt_pk_bf16_f32 v118, v94, v110
    v_cvt_pk_bf16_f32 v119, v95, v111
    ds_write_b32 v8, v112 offset:4096
    ds_write_b32 v8, v113 offset:10240
    ds_write_b32 v8, v114 offset:16384
    ds_write_b32 v8, v115 offset:22528
    ds_write_b32 v8, v116 offset:28672
    ds_write_b32 v8, v117 offset:34816
    ds_write_b32 v8, v118 offset:40960
    ds_write_b32 v8, v119 offset:47104
    v_mov_b32 v10, 1
    s_waitcnt lgkmcnt(0)
    s_mov_b64 exec, 1
    ds_add_u32 v6, v10 offset:4
    s_mov_b64 exec, -1
    v_bfe_u32 v8, v3, 1, 2
    v_xor_b32 v8, v8, v2
    v_lshlrev_b32 v8, 4, v8
    v_lshl_add_u32 v8, v3, 6, v8
    s_mul_i32 s66, s3, 12288
    v_add_u32 v8, s66, v8
    v_lshrrev_b32 v12, 1, v2
    v_mul_u32_u24 v12, 41984, v12
    v_and_b32 v13, 1, v2
    v_mul_u32_u24 v11, 5248, v13
    v_add_u32 v12, v12, v11
    v_lshl_add_u32 v12, v3, 4, v12
    s_mul_i32 s66, s28, 17
    s_add_u32 s67, s66, s3
    s_mul_i32 s67, s67, 10496
    s_and_b32 s68, s30, 1
    s_lshl_b32 s68, s68, 1
    s_lshr_b32 s69, s30, 1
    s_add_u32 s68, s68, s69
    s_mul_i32 s68, s68, 1280
    s_add_u32 s68, s68, 8388736
    s_add_u32 s67, s67, s68
    s_sub_u32 s69, s67, 16
    s_add_u32 s66, s66, 16
    s_mul_i32 s66, s66, 10496
    s_add_u32 s66, s66, s68
    s_add_u32 s70, s67, 83968
    v_mov_b32 v14, 149504
    s_mov_b32 s100, 0
L_zw:
    ds_read_b32 v15, v14 offset:4
    s_waitcnt lgkmcnt(0)
    v_readfirstlane_b32 s78, v15
    s_cmp_lt_u32 s78, 4
    s_cbranch_scc0 L_zw_ok
    s_add_u32 s100, s100, 1
    s_cmp_lt_u32 s100, 8388608
    s_sleep 3
    s_cbranch_scc1 L_zw
L_zw_ok:
    ds_read_b128 v[40:43], v8 offset:0
    ds_read_b128 v[44:47], v8 offset:1024
    ds_read_b128 v[48:51], v8 offset:2048
    ds_read_b128 v[52:55], v8 offset:3072
    ds_read_b128 v[56:59], v8 offset:4096
    ds_read_b128 v[60:63], v8 offset:6144
    ds_read_b128 v[64:67], v8 offset:7168
    ds_read_b128 v[68:71], v8 offset:8192
    ds_read_b128 v[72:75], v8 offset:9216
    ds_read_b128 v[76:79], v8 offset:10240
    ds_read_b128 v[120:123], v8 offset:5120
    ds_read_b128 v[124:127], v8 offset:11264
    s_waitcnt lgkmcnt(0)
    s_mov_b64 exec, 1
    ds_add_u32 v6, v10 offset:8
    s_mov_b64 exec, -1
    v_mov_b32 v8, v12
    v_mov_b32 v10, v11
    v_mfma_f32_16x16x32_bf16 v[176:179], v[136:139], v[40:43], 0
    v_mfma_f32_16x16x32_bf16 v[216:219], v[152:155], v[40:43], 0
    v_mfma_f32_16x16x32_bf16 v[196:199], v[140:143], v[40:43], 0
    v_mfma_f32_16x16x32_bf16 v[236:239], v[156:159], v[40:43], 0
    v_mfma_f32_16x16x32_bf16 v[176:179], v[144:147], v[60:63], v[176:179]
    v_mfma_f32_16x16x32_bf16 v[216:219], v[136:139], v[60:63], v[216:219]
    v_mfma_f32_16x16x32_bf16 v[196:199], v[148:151], v[60:63], v[196:199]
    v_mfma_f32_16x16x32_bf16 v[236:239], v[140:143], v[60:63], v[236:239]
    v_mfma_f32_16x16x32_bf16 v[180:183], v[136:139], v[44:47], 0
    v_mfma_f32_16x16x32_bf16 v[220:223], v[152:155], v[44:47], 0
    v_mfma_f32_16x16x32_bf16 v[200:203], v[140:143], v[44:47], 0
    v_mfma_f32_16x16x32_bf16 v[240:243], v[156:159], v[44:47], 0
    v_mfma_f32_16x16x32_bf16 v[180:183], v[144:147], v[64:67], v[180:183]
    v_mfma_f32_16x16x32_bf16 v[220:223], v[136:139], v[64:67], v[220:223]
    v_mfma_f32_16x16x32_bf16 v[200:203], v[148:151], v[64:67], v[200:203]
    v_mfma_f32_16x16x32_bf16 v[240:243], v[140:143], v[64:67], v[240:243]
    v_mfma_f32_16x16x32_bf16 v[184:187], v[136:139], v[48:51], 0
    v_cvt_pk_bf16_f32 v80, v176, v216
    v_cvt_pk_bf16_f32 v81, v177, v217
    v_mfma_f32_16x16x32_bf16 v[224:227], v[152:155], v[48:51], 0
    v_cvt_pk_bf16_f32 v82, v178, v218
    v_cvt_pk_bf16_f32 v83, v179, v219
    v_mfma_f32_16x16x32_bf16 v[204:207], v[140:143], v[48:51], 0
    buffer_store_dwordx4 v[80:83], v8, s[12:15], s67 offen offset:0 sc1
    v_cvt_pk_bf16_f32 v100, v196, v236
    v_mfma_f32_16x16x32_bf16 v[244:247], v[156:159], v[48:51], 0
    v_cvt_pk_bf16_f32 v101, v197, v237
    v_cvt_pk_bf16_f32 v102, v198, v238
    v_mfma_f32_16x16x32_bf16 v[184:187], v[144:147], v[68:71], v[184:187]
    v_cvt_pk_bf16_f32 v103, v199, v239
    buffer_store_dwordx4 v[100:103], v8, s[12:15], s70 offen offset:0 sc1
    v_mfma_f32_16x16x32_bf16 v[224:227], v[136:139], v[68:71], v[224:227]
    v_mfma_f32_16x16x32_bf16 v[204:207], v[148:151], v[68:71], v[204:207]
    v_mfma_f32_16x16x32_bf16 v[244:247], v[140:143], v[68:71], v[244:247]
    v_mfma_f32_16x16x32_bf16 v[188:191], v[136:139], v[52:55], 0
    v_cvt_pk_bf16_f32 v84, v180, v220
    v_cvt_pk_bf16_f32 v85, v181, v221
    v_mfma_f32_16x16x32_bf16 v[228:231], v[152:155], v[52:55], 0
    v_cvt_pk_bf16_f32 v86, v182, v222
    v_cvt_pk_bf16_f32 v87, v183, v223
    v_mfma_f32_16x16x32_bf16 v[208:211], v[140:143], v[52:55], 0
    buffer_store_dwordx4 v[84:87], v8, s[12:15], s67 offen offset:256 sc1
    v_cvt_pk_bf16_f32 v104, v200, v240
    v_mfma_f32_16x16x32_bf16 v[248:251], v[156:159], v[52:55], 0
    v_cvt_pk_bf16_f32 v105, v201, v241
    v_cvt_pk_bf16_f32 v106, v202, v242
    v_mfma_f32_16x16x32_bf16 v[188:191], v[144:147], v[72:75], v[188:191]
    v_cvt_pk_bf16_f32 v107, v203, v243
    buffer_store_dwordx4 v[104:107], v8, s[12:15], s70 offen offset:256 sc1
    v_mfma_f32_16x16x32_bf16 v[228:231], v[136:139], v[72:75], v[228:231]
    v_mfma_f32_16x16x32_bf16 v[208:211], v[148:151], v[72:75], v[208:211]
    v_mfma_f32_16x16x32_bf16 v[248:251], v[140:143], v[72:75], v[248:251]
    v_mfma_f32_16x16x32_bf16 v[192:195], v[136:139], v[56:59], 0
    v_cvt_pk_bf16_f32 v88, v184, v224
    v_cvt_pk_bf16_f32 v89, v185, v225
    v_mfma_f32_16x16x32_bf16 v[232:235], v[152:155], v[56:59], 0
    v_cvt_pk_bf16_f32 v90, v186, v226
    v_cvt_pk_bf16_f32 v91, v187, v227
    v_mfma_f32_16x16x32_bf16 v[212:215], v[140:143], v[56:59], 0
    buffer_store_dwordx4 v[88:91], v8, s[12:15], s67 offen offset:512 sc1
    v_cvt_pk_bf16_f32 v108, v204, v244
    v_mfma_f32_16x16x32_bf16 v[252:255], v[156:159], v[56:59], 0
    v_cvt_pk_bf16_f32 v109, v205, v245
    v_cvt_pk_bf16_f32 v110, v206, v246
    v_mfma_f32_16x16x32_bf16 v[192:195], v[144:147], v[76:79], v[192:195]
    v_cvt_pk_bf16_f32 v111, v207, v247
    buffer_store_dwordx4 v[108:111], v8, s[12:15], s70 offen offset:512 sc1
    v_mfma_f32_16x16x32_bf16 v[232:235], v[136:139], v[76:79], v[232:235]
    v_mfma_f32_16x16x32_bf16 v[212:215], v[148:151], v[76:79], v[212:215]
    v_mfma_f32_16x16x32_bf16 v[252:255], v[140:143], v[76:79], v[252:255]
    s_cmp_lg_u32 s30, 0
    s_cbranch_scc1 L_v0a
    v_mfma_f32_16x16x32_bf16 v[160:163], v[136:139], v[120:123], 0
    v_mfma_f32_16x16x32_bf16 v[168:171], v[152:155], v[120:123], 0
    v_mfma_f32_16x16x32_bf16 v[164:167], v[140:143], v[120:123], 0
    v_mfma_f32_16x16x32_bf16 v[172:175], v[156:159], v[120:123], 0
    v_mfma_f32_16x16x32_bf16 v[160:163], v[144:147], v[124:127], v[160:163]
    v_mfma_f32_16x16x32_bf16 v[168:171], v[136:139], v[124:127], v[168:171]
    v_mfma_f32_16x16x32_bf16 v[164:167], v[148:151], v[124:127], v[164:167]
    v_mfma_f32_16x16x32_bf16 v[172:175], v[140:143], v[124:127], v[172:175]
L_v0a:
    v_cvt_pk_bf16_f32 v92, v188, v228
    v_cvt_pk_bf16_f32 v93, v189, v229
    v_cvt_pk_bf16_f32 v94, v190, v230
    v_cvt_pk_bf16_f32 v95, v191, v231
    buffer_store_dwordx4 v[92:95], v8, s[12:15], s67 offen offset:768 sc1
    v_cvt_pk_bf16_f32 v112, v208, v248
    v_cvt_pk_bf16_f32 v113, v209, v249
    v_cvt_pk_bf16_f32 v114, v210, v250
    v_cvt_pk_bf16_f32 v115, v211, v251
    buffer_store_dwordx4 v[112:115], v8, s[12:15], s70 offen offset:768 sc1
    v_cvt_pk_bf16_f32 v96, v192, v232
    v_cvt_pk_bf16_f32 v97, v193, v233
    v_cvt_pk_bf16_f32 v98, v194, v234
    v_cvt_pk_bf16_f32 v99, v195, v235
    buffer_store_dwordx4 v[96:99], v8, s[12:15], s67 offen offset:1024 sc1
    v_cvt_pk_bf16_f32 v116, v212, v252
    v_cvt_pk_bf16_f32 v117, v213, v253
    v_cvt_pk_bf16_f32 v118, v214, v254
    v_cvt_pk_bf16_f32 v119, v215, v255
    buffer_store_dwordx4 v[116:119], v8, s[12:15], s70 offen offset:1024 sc1
    s_cmp_lg_u32 s30, 0
    s_cbranch_scc1 L_v0b
    v_cvt_pk_bf16_f32 v120, v160, v168
    v_cvt_pk_bf16_f32 v121, v161, v169
    v_cvt_pk_bf16_f32 v122, v162, v170
    v_cvt_pk_bf16_f32 v123, v163, v171
    v_cvt_pk_bf16_f32 v124, v164, v172
    v_cvt_pk_bf16_f32 v125, v165, v173
    v_cvt_pk_bf16_f32 v126, v166, v174
    v_cvt_pk_bf16_f32 v127, v167, v175
    s_mov_b32 exec_lo, 0x00010001
    s_mov_b32 exec_hi, 0x00010001
    buffer_store_dwordx4 v[120:123], v8, s[12:15], s69 offen sc1
    s_add_u32 s69, s69, 83968
    buffer_store_dwordx4 v[124:127], v8, s[12:15], s69 offen sc1
    s_mov_b64 exec, -1
L_v0b:
    s_cmp_lg_u32 s3, 0
    s_cbranch_scc1 L_signal
    v_cvt_f32_u32 v62, s28
    v_mul_f32 v62, 0.0625, v62
    v_cos_f32 v63, v62
    v_sin_f32 v64, v62
    v_cmp_gt_u32 vcc, 16, v0
    v_lshlrev_b32 v11, 4, v3
    v_add_u32 v9, v10, v11
    v_mul_f32 v65, v63, v176
    v_fmac_f32 v65, v64, v216
    v_mul_f32 v66, v63, v216
    v_fma_f32 v66, -v64, v176, v66
    v_cvt_pk_bf16_f32 v65, v65, v66
    v_cndmask_b32 v65, v80, v65, vcc
    v_mov_b32 v40, v81
    v_mov_b32 v66, v65
    v_mov_b32 v41, v82
    v_mov_b32 v42, v83
    v_permlane16_swap_b32 v65, v66
    s_nop 1
    v_cndmask_b32 v43, v65, v66, vcc
    v_mul_f32 v65, v63, v180
    v_fmac_f32 v65, v64, v220
    v_mul_f32 v66, v63, v220
    v_fma_f32 v66, -v64, v180, v66
    v_cvt_pk_bf16_f32 v65, v65, v66
    v_cndmask_b32 v65, v84, v65, vcc
    v_mov_b32 v44, v85
    v_mov_b32 v66, v65
    v_mov_b32 v45, v86
    v_mov_b32 v46, v87
    v_permlane16_swap_b32 v65, v66
    s_nop 1
    v_cndmask_b32 v47, v65, v66, vcc
    v_mul_f32 v65, v63, v184
    v_fmac_f32 v65, v64, v224
    v_mul_f32 v66, v63, v224
    v_fma_f32 v66, -v64, v184, v66
    v_cvt_pk_bf16_f32 v65, v65, v66
    v_cndmask_b32 v65, v88, v65, vcc
    v_mov_b32 v48, v89
    v_mov_b32 v66, v65
    v_mov_b32 v49, v90
    v_mov_b32 v50, v91
    v_permlane16_swap_b32 v65, v66
    s_nop 1
    v_cndmask_b32 v51, v65, v66, vcc
    v_mul_f32 v65, v63, v188
    v_fmac_f32 v65, v64, v228
    v_mul_f32 v66, v63, v228
    v_fma_f32 v66, -v64, v188, v66
    v_cvt_pk_bf16_f32 v65, v65, v66
    v_cndmask_b32 v65, v92, v65, vcc
    v_mov_b32 v52, v93
    v_mov_b32 v66, v65
    v_mov_b32 v53, v94
    v_mov_b32 v54, v95
    v_permlane16_swap_b32 v65, v66
    s_nop 1
    v_cndmask_b32 v55, v65, v66, vcc
    v_mul_f32 v65, v63, v192
    v_fmac_f32 v65, v64, v232
    v_mul_f32 v66, v63, v232
    v_fma_f32 v66, -v64, v192, v66
    v_cvt_pk_bf16_f32 v65, v65, v66
    v_cndmask_b32 v65, v96, v65, vcc
    v_mov_b32 v56, v97
    v_mov_b32 v66, v65
    v_mov_b32 v57, v98
    v_mov_b32 v58, v99
    v_permlane16_swap_b32 v65, v66
    s_nop 1
    v_cndmask_b32 v59, v65, v66, vcc
    s_mov_b32 exec_hi, 0
    buffer_store_dwordx4 v[40:43], v9, s[12:15], s66 offen offset:0 sc1
    buffer_store_dwordx4 v[44:47], v9, s[12:15], s66 offen offset:256 sc1
    buffer_store_dwordx4 v[48:51], v9, s[12:15], s66 offen offset:512 sc1
    buffer_store_dwordx4 v[52:55], v9, s[12:15], s66 offen offset:768 sc1
    buffer_store_dwordx4 v[56:59], v9, s[12:15], s66 offen offset:1024 sc1
    s_mov_b64 exec, -1
L_signal:
    s_mov_b32 s79, 0
    s_lshl_b32 s66, s30, 2
    s_add_u32 s66, s66, s3
    s_lshl_b32 s66, s66, 7
    s_lshl_b32 s67, s28, 2
    s_add_u32 s66, s66, s67
    s_add_u32 s66, s66, 11747328
    v_mov_b32 v4, s43
    v_mov_b32 v5, 0
    s_waitcnt vmcnt(0)
    s_mov_b64 exec, 1
    buffer_store_dword v4, v5, s[12:15], s66 offen sc1
    s_mov_b64 exec, -1
L_helper:
    s_barrier
    s_mov_b32 s44, s3
    v_lshlrev_b32 v1, 4, v0
    s_mov_b32 s12, s58
    s_mov_b32 s13, s59
    s_mov_b32 s14, 16777216
    s_mov_b32 s15, 0x00020000
    s_mul_i32 s70, s38, 48
    s_mul_i32 s71, s44, 12
    s_add_u32 s70, s70, s71
    s_mul_i32 s70, s70, 5120
    s_add_u32 s70, s70, 6291456
    s_mul_i32 s73, s44, 10240
    s_cmp_eq_u32 s35, 1
    s_cbranch_scc1 L_hd
    s_add_u32 s72, s39, 0
    s_cmp_ge_u32 s72, 6
    s_cselect_b32 s71, 6, 0
    s_sub_u32 s72, s72, s71
    s_lshl_b32 s72, s72, 1
    s_mul_i32 s72, s72, 5120
    s_add_u32 s72, s72, s70
    s_add_u32 m0, s73, 49152
    s_nop 0
    buffer_load_dwordx4 v1, s[12:15], s72 offen sc1 lds
    s_add_u32 m0, s73, 50176
    s_add_u32 s72, s72, 1024
    buffer_load_dwordx4 v1, s[12:15], s72 offen sc1 lds
    s_add_u32 m0, s73, 51200
    s_add_u32 s72, s72, 1024
    buffer_load_dwordx4 v1, s[12:15], s72 offen sc1 lds
    s_add_u32 m0, s73, 52224
    s_add_u32 s72, s72, 1024
    buffer_load_dwordx4 v1, s[12:15], s72 offen sc1 lds
    s_add_u32 m0, s73, 53248
    s_add_u32 s72, s72, 1024
    buffer_load_dwordx4 v1, s[12:15], s72 offen sc1 lds
    s_add_u32 s72, s39, 1
    s_cmp_ge_u32 s72, 6
    s_cselect_b32 s71, 6, 0
    s_sub_u32 s72, s72, s71
    s_lshl_b32 s72, s72, 1
    s_mul_i32 s72, s72, 5120
    s_add_u32 s72, s72, s70
    s_add_u32 m0, s73, 54272
    s_nop 0
    buffer_load_dwordx4 v1, s[12:15], s72 offen sc1 lds
    s_add_u32 m0, s73, 55296
    s_add_u32 s72, s72, 1024
    buffer_load_dwordx4 v1, s[12:15], s72 offen sc1 lds
    s_add_u32 m0, s73, 56320
    s_add_u32 s72, s72, 1024
    buffer_load_dwordx4 v1, s[12:15], s72 offen sc1 lds
    s_add_u32 m0, s73, 57344
    s_add_u32 s72, s72, 1024
    buffer_load_dwordx4 v1, s[12:15], s72 offen sc1 lds
    s_add_u32 m0, s73, 58368
    s_add_u32 s72, s72, 1024
    buffer_load_dwordx4 v1, s[12:15], s72 offen sc1 lds
    s_add_u32 s72, s39, 2
    s_cmp_ge_u32 s72, 6
    s_cselect_b32 s71, 6, 0
    s_sub_u32 s72, s72, s71
    s_lshl_b32 s72, s72, 1
    s_mul_i32 s72, s72, 5120
    s_add_u32 s72, s72, s70
    s_add_u32 m0, s73, 98304
    s_nop 0
    buffer_load_dwordx4 v1, s[12:15], s72 offen sc1 lds
    s_add_u32 m0, s73, 99328
    s_add_u32 s72, s72, 1024
    buffer_load_dwordx4 v1, s[12:15], s72 offen sc1 lds
    s_add_u32 m0, s73, 100352
    s_add_u32 s72, s72, 1024
    buffer_load_dwordx4 v1, s[12:15], s72 offen sc1 lds
    s_add_u32 m0, s73, 101376
    s_add_u32 s72, s72, 1024
    buffer_load_dwordx4 v1, s[12:15], s72 offen sc1 lds
    s_add_u32 m0, s73, 102400
    s_add_u32 s72, s72, 1024
    buffer_load_dwordx4 v1, s[12:15], s72 offen sc1 lds
    s_add_u32 s72, s39, 3
    s_cmp_ge_u32 s72, 6
    s_cselect_b32 s71, 6, 0
    s_sub_u32 s72, s72, s71
    s_lshl_b32 s72, s72, 1
    s_mul_i32 s72, s72, 5120
    s_add_u32 s72, s72, s70
    s_add_u32 m0, s73, 103424
    s_nop 0
    buffer_load_dwordx4 v1, s[12:15], s72 offen sc1 lds
    s_add_u32 m0, s73, 104448
    s_add_u32 s72, s72, 1024
    buffer_load_dwordx4 v1, s[12:15], s72 offen sc1 lds
    s_add_u32 m0, s73, 105472
    s_add_u32 s72, s72, 1024
    buffer_load_dwordx4 v1, s[12:15], s72 offen sc1 lds
    s_add_u32 m0, s73, 106496
    s_add_u32 s72, s72, 1024
    buffer_load_dwordx4 v1, s[12:15], s72 offen sc1 lds
    s_add_u32 m0, s73, 107520
    s_add_u32 s72, s72, 1024
    buffer_load_dwordx4 v1, s[12:15], s72 offen sc1 lds
    s_add_u32 s72, s39, 4
    s_cmp_ge_u32 s72, 6
    s_cselect_b32 s71, 6, 0
    s_sub_u32 s72, s72, s71
    s_lshl_b32 s72, s72, 1
    s_mul_i32 s72, s72, 5120
    s_add_u32 s72, s72, s70
    s_add_u32 m0, s73, 0
    s_nop 0
    buffer_load_dwordx4 v1, s[12:15], s72 offen sc1 lds
    s_add_u32 m0, s73, 1024
    s_add_u32 s72, s72, 1024
    buffer_load_dwordx4 v1, s[12:15], s72 offen sc1 lds
    s_add_u32 m0, s73, 2048
    s_add_u32 s72, s72, 1024
    buffer_load_dwordx4 v1, s[12:15], s72 offen sc1 lds
    s_add_u32 m0, s73, 3072
    s_add_u32 s72, s72, 1024
    buffer_load_dwordx4 v1, s[12:15], s72 offen sc1 lds
    s_add_u32 m0, s73, 4096
    s_add_u32 s72, s72, 1024
    buffer_load_dwordx4 v1, s[12:15], s72 offen sc1 lds
    s_add_u32 s72, s39, 5
    s_cmp_ge_u32 s72, 6
    s_cselect_b32 s71, 6, 0
    s_sub_u32 s72, s72, s71
    s_lshl_b32 s72, s72, 1
    s_mul_i32 s72, s72, 5120
    s_add_u32 s72, s72, s70
    s_add_u32 m0, s73, 5120
    s_nop 0
    buffer_load_dwordx4 v1, s[12:15], s72 offen sc1 lds
    s_add_u32 m0, s73, 6144
    s_add_u32 s72, s72, 1024
    buffer_load_dwordx4 v1, s[12:15], s72 offen sc1 lds
    s_add_u32 m0, s73, 7168
    s_add_u32 s72, s72, 1024
    buffer_load_dwordx4 v1, s[12:15], s72 offen sc1 lds
    s_add_u32 m0, s73, 8192
    s_add_u32 s72, s72, 1024
    buffer_load_dwordx4 v1, s[12:15], s72 offen sc1 lds
    s_add_u32 m0, s73, 9216
    s_add_u32 s72, s72, 1024
    buffer_load_dwordx4 v1, s[12:15], s72 offen sc1 lds
    s_branch L_hf
L_hd:
    s_add_u32 s72, s39, 4
    s_cmp_ge_u32 s72, 6
    s_cselect_b32 s71, 6, 0
    s_sub_u32 s72, s72, s71
    s_lshl_b32 s72, s72, 1
    s_mul_i32 s72, s72, 5120
    s_add_u32 s72, s72, s70
    s_add_u32 m0, s73, 0
    s_nop 0
    buffer_load_dwordx4 v1, s[12:15], s72 offen sc1 lds
    s_add_u32 m0, s73, 1024
    s_add_u32 s72, s72, 1024
    buffer_load_dwordx4 v1, s[12:15], s72 offen sc1 lds
    s_add_u32 m0, s73, 2048
    s_add_u32 s72, s72, 1024
    buffer_load_dwordx4 v1, s[12:15], s72 offen sc1 lds
    s_add_u32 m0, s73, 3072
    s_add_u32 s72, s72, 1024
    buffer_load_dwordx4 v1, s[12:15], s72 offen sc1 lds
    s_add_u32 m0, s73, 4096
    s_add_u32 s72, s72, 1024
    buffer_load_dwordx4 v1, s[12:15], s72 offen sc1 lds
    s_add_u32 s72, s39, 5
    s_cmp_ge_u32 s72, 6
    s_cselect_b32 s71, 6, 0
    s_sub_u32 s72, s72, s71
    s_lshl_b32 s72, s72, 1
    s_mul_i32 s72, s72, 5120
    s_add_u32 s72, s72, s70
    s_add_u32 m0, s73, 5120
    s_nop 0
    buffer_load_dwordx4 v1, s[12:15], s72 offen sc1 lds
    s_add_u32 m0, s73, 6144
    s_add_u32 s72, s72, 1024
    buffer_load_dwordx4 v1, s[12:15], s72 offen sc1 lds
    s_add_u32 m0, s73, 7168
    s_add_u32 s72, s72, 1024
    buffer_load_dwordx4 v1, s[12:15], s72 offen sc1 lds
    s_add_u32 m0, s73, 8192
    s_add_u32 s72, s72, 1024
    buffer_load_dwordx4 v1, s[12:15], s72 offen sc1 lds
    s_add_u32 m0, s73, 9216
    s_add_u32 s72, s72, 1024
    buffer_load_dwordx4 v1, s[12:15], s72 offen sc1 lds
L_hf:
    s_waitcnt vmcnt(0)
    v_mov_b32 v4, 149504
    v_mov_b32 v5, 1
    s_waitcnt lgkmcnt(0)
    s_mov_b64 exec, 1
    ds_add_u32 v4, v5 offset:36
    s_mov_b64 exec, -1
    s_cmp_eq_u32 s79, 1
    s_cbranch_scc1 L_vdone
    s_cmp_lg_u32 s3, 3
    s_cbranch_scc1 L_vwait
    s_mov_b32 s79, 0
L_pollv:
    buffer_load_dword v53, v27, s[12:15], s60 offen sc1
    s_waitcnt vmcnt(0)
    v_cmp_ne_u32 vcc, s43, v53
    s_cmp_eq_u64 vcc, 0
    s_cbranch_scc1 L_pollv_ok
    s_add_u32 s79, s79, 1
    s_cmp_ge_u32 s79, 1048576
    s_cbranch_scc1 L_pollv_ok
    s_sleep 4
    s_branch L_pollv
L_pollv_ok:
    v_mov_b32 v40, 149504
    v_mov_b32 v41, 1
    s_waitcnt lgkmcnt(0)
    s_mov_b64 exec, 1
    ds_add_u32 v40, v41 offset:28
    s_mov_b64 exec, -1
L_vwait:
    v_mov_b32 v40, 149504
    s_mov_b32 s100, 0
L_vc:
    ds_read_b32 v41, v40 offset:28
    s_waitcnt lgkmcnt(0)
    v_readfirstlane_b32 s78, v41
    s_cmp_lt_u32 s78, 1
    s_cbranch_scc0 L_vc_ok
    s_add_u32 s100, s100, 1
    s_cmp_lt_u32 s100, 8388608
    s_sleep 3
    s_cbranch_scc1 L_vc
L_vc_ok:
    v_mov_b32 v40, 149504
    s_mov_b32 s100, 0
L_vgo:
    ds_read_b32 v41, v40 offset:40
    s_waitcnt lgkmcnt(0)
    v_readfirstlane_b32 s78, v41
    s_cmp_lt_u32 s78, 1
    s_cbranch_scc0 L_vgo_ok
    s_add_u32 s100, s100, 1
    s_cmp_lt_u32 s100, 8388608
    s_sleep 3
    s_cbranch_scc1 L_vgo
L_vgo_ok:
    s_mov_b32 s72, s56
    buffer_load_dwordx4 v[128:131], v25, s[12:15], s72 offen sc1
    s_add_u32 s72, s72, 178432
    buffer_load_dwordx4 v[132:135], v25, s[12:15], s72 offen sc1
    s_add_u32 s72, s72, 178432
    buffer_load_dwordx4 v[136:139], v25, s[12:15], s72 offen sc1
    s_add_u32 s72, s72, 178432
    buffer_load_dwordx4 v[140:143], v25, s[12:15], s72 offen sc1
    s_cmp_lg_u32 s3, 0
    s_cbranch_scc1 L_vl_17
    s_mov_b32 s72, s56
    buffer_load_dwordx4 v[144:147], v26, s[12:15], s72 offen sc1
    s_add_u32 s72, s72, 178432
    buffer_load_dwordx4 v[148:151], v26, s[12:15], s72 offen sc1
    s_add_u32 s72, s72, 178432
    buffer_load_dwordx4 v[152:155], v26, s[12:15], s72 offen sc1
    s_add_u32 s72, s72, 178432
    buffer_load_dwordx4 v[156:159], v26, s[12:15], s72 offen sc1
L_vl_17:
L_vdone:
    v_lshrrev_b32 v4, 2, v3
    v_and_b32 v5, 3, v3
    v_lshl_add_u32 v7, v5, 2, v4
    s_mul_i32 s66, s55, 15
    v_xor_b32 v4, s66, v7
    v_cvt_f32_u32 v4, v4
    v_mul_f32 v4, 0.0625, v4
    v_lshlrev_b32 v5, 2, v2
    v_cvt_f32_u32 v5, v5
    v_add_f32 v52, 0.0, v5
    v_mul_f32 v52, v52, v4
    v_cos_f32 v53, v52
    v_sin_f32 v54, v52
    s_nop 0
    v_cvt_pk_bf16_f32 v8, v53, v54
    v_add_f32 v52, 1.0, v5
    v_mul_f32 v52, v52, v4
    v_cos_f32 v53, v52
    v_sin_f32 v54, v52
    s_nop 0
    v_cvt_pk_bf16_f32 v9, v53, v54
    v_add_f32 v52, 2.0, v5
    v_mul_f32 v52, v52, v4
    v_cos_f32 v53, v52
    v_sin_f32 v54, v52
    s_nop 0
    v_cvt_pk_bf16_f32 v10, v53, v54
    v_add_f32 v52, 3.0, v5
    v_mul_f32 v52, v52, v4
    v_cos_f32 v53, v52
    v_sin_f32 v54, v52
    s_nop 0
    v_cvt_pk_bf16_f32 v11, v53, v54
    s_mov_b32 s47, 1088
    s_cmp_eq_u32 s55, 1
    s_cselect_b32 s47, 4294966208, s47
    v_mul_u32_u24 v56, 272, v2
    v_lshl_add_u32 v56, v3, 4, v56
    s_mul_i32 s66, s55, 3264
    v_add_u32 v56, s66, v56
    v_add_u32 v57, s47, v56
    v_add_u32 v58, s47, v57
    v_add_u32 v59, s47, v58
    s_cmp_eq_u32 s3, 1
    s_mov_b32 s73, 40960
    s_cselect_b32 s73, 90176, s73
    s_cmp_eq_u32 s3, 2
    s_cselect_b32 s73, 139392, s73
    s_cmp_eq_u32 s3, 3
    s_cselect_b32 s73, 151744, s73
    s_waitcnt vmcnt(0)
    s_cmp_lg_u32 s3, 0
    s_cbranch_scc1 L_spec1
    s_mov_b32 s74, 156160
    v_mov_b32 v64, v144
    v_mov_b32 v65, v148
    v_mov_b32 v66, v152
    v_mov_b32 v67, v156
    v_mov_b32 v68, v145
    v_mov_b32 v69, v149
    v_mov_b32 v70, v153
    v_mov_b32 v71, v157
    v_mov_b32 v72, v146
    v_mov_b32 v73, v150
    v_mov_b32 v74, v154
    v_mov_b32 v75, v158
    v_mov_b32 v76, v147
    v_mov_b32 v77, v151
    v_mov_b32 v78, v155
    v_mov_b32 v79, v159
    s_nop 1
    v_mfma_f32_16x16x32_bf16 v[80:83], v[64:67], v[8:11], 0
    v_mfma_f32_16x16x32_bf16 v[84:87], v[68:71], v[8:11], 0
    v_mfma_f32_16x16x32_bf16 v[88:91], v[72:75], v[8:11], 0
    v_mfma_f32_16x16x32_bf16 v[92:95], v[76:79], v[8:11], 0
    v_add_u32 v40, s74, v56
    v_add_u32 v41, s74, v57
    v_add_u32 v42, s74, v58
    v_add_u32 v43, s74, v59
    s_nop 5
    ds_write_b128 v40, v[80:83]
    ds_write_b128 v41, v[84:87]
    ds_write_b128 v42, v[88:91]
    ds_write_b128 v43, v[92:95]
L_spec1:
    v_mov_b32 v64, v128
    v_mov_b32 v65, v132
    v_mov_b32 v66, v136
    v_mov_b32 v67, v140
    v_mov_b32 v68, v129
    v_mov_b32 v69, v133
    v_mov_b32 v70, v137
    v_mov_b32 v71, v141
    v_mov_b32 v72, v130
    v_mov_b32 v73, v134
    v_mov_b32 v74, v138
    v_mov_b32 v75, v142
    v_mov_b32 v76, v131
    v_mov_b32 v77, v135
    v_mov_b32 v78, v139
    v_mov_b32 v79, v143
    s_nop 1
    v_mfma_f32_16x16x32_bf16 v[80:83], v[64:67], v[8:11], 0
    v_mfma_f32_16x16x32_bf16 v[84:87], v[68:71], v[8:11], 0
    v_mfma_f32_16x16x32_bf16 v[88:91], v[72:75], v[8:11], 0
    v_mfma_f32_16x16x32_bf16 v[92:95], v[76:79], v[8:11], 0
    v_add_u32 v40, s73, v56
    v_add_u32 v41, s73, v57
    v_add_u32 v42, s73, v58
    v_add_u32 v43, s73, v59
    s_nop 5
    ds_write_b128 v40, v[80:83]
    ds_write_b128 v41, v[84:87]
    ds_write_b128 v42, v[88:91]
    ds_write_b128 v43, v[92:95]
    v_lshlrev_b32 v96, 16, v32
    v_and_b32 v97, 0xffff0000, v32
    v_lshlrev_b32 v98, 16, v33
    v_and_b32 v99, 0xffff0000, v33
    v_lshlrev_b32 v100, 16, v34
    v_and_b32 v101, 0xffff0000, v34
    v_lshlrev_b32 v102, 16, v35
    v_and_b32 v103, 0xffff0000, v35
    v_lshlrev_b32 v104, 16, v36
    v_and_b32 v105, 0xffff0000, v36
    v_lshlrev_b32 v106, 16, v37
    v_and_b32 v107, 0xffff0000, v37
    v_lshlrev_b32 v108, 16, v38
    v_and_b32 v109, 0xffff0000, v38
    v_lshlrev_b32 v110, 16, v39
    v_and_b32 v111, 0xffff0000, v39
    v_lshlrev_b32 v112, 16, v28
    v_and_b32 v113, 0xffff0000, v28
    v_lshlrev_b32 v114, 16, v29
    v_and_b32 v115, 0xffff0000, v29
    v_lshlrev_b32 v116, 16, v30
    v_and_b32 v117, 0xffff0000, v30
    v_lshlrev_b32 v118, 16, v31
    v_and_b32 v119, 0xffff0000, v31
    v_mov_b32 v40, 149504
    v_mov_b32 v41, 1
    s_waitcnt lgkmcnt(0)
    s_mov_b64 exec, 1
    ds_add_u32 v40, v41 offset:52
    s_mov_b64 exec, -1
    v_mov_b32 v40, 149504
    s_mov_b32 s100, 0
L_spw:
    ds_read_b32 v41, v40 offset:52
    s_waitcnt lgkmcnt(0)
    v_readfirstlane_b32 s78, v41
    s_cmp_lt_u32 s78, 4
    s_cbranch_scc0 L_spw_ok
    s_add_u32 s100, s100, 1
    s_cmp_lt_u32 s100, 8388608
    s_sleep 3
    s_cbranch_scc1 L_spw
L_spw_ok:
    ds_read_b128 v[128:131], v21
    ds_read_b128 v[132:135], v21 offset:272
    s_waitcnt lgkmcnt(0)
    v_pk_add_f32 v[128:129], v[128:129], v[104:105]
    v_pk_add_f32 v[130:131], v[130:131], v[106:107]
    v_pk_add_f32 v[132:133], v[132:133], v[108:109]
    v_pk_add_f32 v[134:135], v[134:135], v[110:111]
    ds_write_b128 v21, v[128:131]
    ds_write_b128 v21, v[132:135] offset:272
L_final:
    s_waitcnt lgkmcnt(0)
    s_barrier
    ds_read_b128 v[128:131], v16 offset:0
    ds_read_b128 v[132:135], v16 offset:272
    ds_read_b128 v[136:139], v16 offset:10240
    ds_read_b128 v[140:143], v16 offset:10512
    ds_read_b128 v[144:147], v16 offset:20480
    ds_read_b128 v[148:151], v16 offset:20752
    ds_read_b128 v[152:155], v16 offset:30720
    ds_read_b128 v[156:159], v16 offset:30992
    ds_read_b128 v[160:163], v18 offset:0
    ds_read_b128 v[164:167], v18 offset:272
    s_cmp_ge_u32 s3, 2
    s_cbranch_scc1 L_fin8
    ds_read_b128 v[168:171], v22 offset:0
    ds_read_b128 v[172:175], v22 offset:272
    ds_read_b128 v[176:179], v22 offset:10240
    ds_read_b128 v[180:183], v22 offset:10512
    ds_read_b128 v[184:187], v22 offset:20480
    ds_read_b128 v[188:191], v22 offset:20752
    ds_read_b128 v[192:195], v22 offset:30720
    ds_read_b128 v[196:199], v22 offset:30992
    ds_read_b128 v[200:203], v24 offset:0
    ds_read_b128 v[204:207], v24 offset:272
    s_waitcnt lgkmcnt(15)
    v_pk_add_f32 v[96:97], v[96:97], v[128:129]
    v_pk_add_f32 v[98:99], v[98:99], v[130:131]
    v_pk_add_f32 v[100:101], v[100:101], v[132:133]
    v_pk_add_f32 v[102:103], v[102:103], v[134:135]
    s_waitcnt lgkmcnt(15)
    v_pk_add_f32 v[96:97], v[96:97], v[136:137]
    v_pk_add_f32 v[98:99], v[98:99], v[138:139]
    v_pk_add_f32 v[100:101], v[100:101], v[140:141]
    v_pk_add_f32 v[102:103], v[102:103], v[142:143]
    s_waitcnt lgkmcnt(14)
    v_pk_add_f32 v[96:97], v[96:97], v[144:145]
    v_pk_add_f32 v[98:99], v[98:99], v[146:147]
    v_pk_add_f32 v[100:101], v[100:101], v[148:149]
    v_pk_add_f32 v[102:103], v[102:103], v[150:151]
    s_waitcnt lgkmcnt(12)
    v_pk_add_f32 v[96:97], v[96:97], v[152:153]
    v_pk_add_f32 v[98:99], v[98:99], v[154:155]
    v_pk_add_f32 v[100:101], v[100:101], v[156:157]
    v_pk_add_f32 v[102:103], v[102:103], v[158:159]
    s_waitcnt lgkmcnt(10)
    v_pk_add_f32 v[96:97], v[96:97], v[160:161]
    v_pk_add_f32 v[98:99], v[98:99], v[162:163]
    v_pk_add_f32 v[100:101], v[100:101], v[164:165]
    v_pk_add_f32 v[102:103], v[102:103], v[166:167]
    v_cvt_pk_bf16_f32 v128, v96, v97
    v_cvt_pk_bf16_f32 v129, v98, v99
    v_cvt_pk_bf16_f32 v130, v100, v101
    v_cvt_pk_bf16_f32 v131, v102, v103
    buffer_store_dwordx4 v[128:131], v17, s[16:19], 0 offen sc1
    s_waitcnt lgkmcnt(8)
    v_pk_add_f32 v[112:113], v[112:113], v[168:169]
    v_pk_add_f32 v[114:115], v[114:115], v[170:171]
    v_pk_add_f32 v[116:117], v[116:117], v[172:173]
    v_pk_add_f32 v[118:119], v[118:119], v[174:175]
    s_waitcnt lgkmcnt(6)
    v_pk_add_f32 v[112:113], v[112:113], v[176:177]
    v_pk_add_f32 v[114:115], v[114:115], v[178:179]
    v_pk_add_f32 v[116:117], v[116:117], v[180:181]
    v_pk_add_f32 v[118:119], v[118:119], v[182:183]
    s_waitcnt lgkmcnt(4)
    v_pk_add_f32 v[112:113], v[112:113], v[184:185]
    v_pk_add_f32 v[114:115], v[114:115], v[186:187]
    v_pk_add_f32 v[116:117], v[116:117], v[188:189]
    v_pk_add_f32 v[118:119], v[118:119], v[190:191]
    s_waitcnt lgkmcnt(2)
    v_pk_add_f32 v[112:113], v[112:113], v[192:193]
    v_pk_add_f32 v[114:115], v[114:115], v[194:195]
    v_pk_add_f32 v[116:117], v[116:117], v[196:197]
    v_pk_add_f32 v[118:119], v[118:119], v[198:199]
    s_waitcnt lgkmcnt(0)
    v_pk_add_f32 v[112:113], v[112:113], v[200:201]
    v_pk_add_f32 v[114:115], v[114:115], v[202:203]
    v_pk_add_f32 v[116:117], v[116:117], v[204:205]
    v_pk_add_f32 v[118:119], v[118:119], v[206:207]
    v_cvt_pk_bf16_f32 v168, v112, v113
    v_cvt_pk_bf16_f32 v169, v114, v115
    v_cvt_pk_bf16_f32 v170, v116, v117
    v_cvt_pk_bf16_f32 v171, v118, v119
    buffer_store_dwordx4 v[168:171], v23, s[16:19], 0 offen sc1
    s_branch L_fin2
L_fin8:
    s_waitcnt lgkmcnt(8)
    v_pk_add_f32 v[96:97], v[96:97], v[128:129]
    v_pk_add_f32 v[98:99], v[98:99], v[130:131]
    v_pk_add_f32 v[100:101], v[100:101], v[132:133]
    v_pk_add_f32 v[102:103], v[102:103], v[134:135]
    s_waitcnt lgkmcnt(6)
    v_pk_add_f32 v[96:97], v[96:97], v[136:137]
    v_pk_add_f32 v[98:99], v[98:99], v[138:139]
    v_pk_add_f32 v[100:101], v[100:101], v[140:141]
    v_pk_add_f32 v[102:103], v[102:103], v[142:143]
    s_waitcnt lgkmcnt(4)
    v_pk_add_f32 v[96:97], v[96:97], v[144:145]
    v_pk_add_f32 v[98:99], v[98:99], v[146:147]
    v_pk_add_f32 v[100:101], v[100:101], v[148:149]
    v_pk_add_f32 v[102:103], v[102:103], v[150:151]
    s_waitcnt lgkmcnt(2)
    v_pk_add_f32 v[96:97], v[96:97], v[152:153]
    v_pk_add_f32 v[98:99], v[98:99], v[154:155]
    v_pk_add_f32 v[100:101], v[100:101], v[156:157]
    v_pk_add_f32 v[102:103], v[102:103], v[158:159]
    s_waitcnt lgkmcnt(0)
    v_pk_add_f32 v[96:97], v[96:97], v[160:161]
    v_pk_add_f32 v[98:99], v[98:99], v[162:163]
    v_pk_add_f32 v[100:101], v[100:101], v[164:165]
    v_pk_add_f32 v[102:103], v[102:103], v[166:167]
    v_cvt_pk_bf16_f32 v128, v96, v97
    v_cvt_pk_bf16_f32 v129, v98, v99
    v_cvt_pk_bf16_f32 v130, v100, v101
    v_cvt_pk_bf16_f32 v131, v102, v103
    buffer_store_dwordx4 v[128:131], v17, s[16:19], 0 offen sc1
L_fin2:
    s_endpgm
L_done:
    s_endpgm
.section .rodata,"a"
.p2align 6
.amdhsa_kernel parallel_sum__spectral_fnet__swiglu_ffn__prompt_kernel
  .amdhsa_next_free_vgpr 256
  .amdhsa_next_free_sgpr 102
  .amdhsa_accum_offset 256
  .amdhsa_group_segment_fixed_size 0
  .amdhsa_kernarg_size 96
  .amdhsa_user_sgpr_count 2
  .amdhsa_user_sgpr_kernarg_segment_ptr 1
  .amdhsa_system_sgpr_workgroup_id_x 1
.end_amdhsa_kernel
```
